```python
import torch

def _softmax(x, axis=-1):
    return torch.softmax(x, dim=axis)
def _gelu(x):
    return torch.nn.functional.gelu(x, approximate="tanh")
def _silu(x):
    return torch.nn.functional.silu(x)
def _sigmoid(x):
    return torch.sigmoid(x)
def _layernorm(x, axis=-1, eps=1e-5):
    m = x.mean(dim=axis, keepdim=True)
    v = x.var(dim=axis, keepdim=True, unbiased=False)
    return (x - m) / torch.sqrt(v + eps)
def _scatter_add(tgt, idx, src, axis=0):
    return tgt.clone().index_add_(axis, idx, src)
def _segment_sum(src, seg, n):
    out = torch.zeros((n,) + src.shape[1:], dtype=src.dtype)
    return out.index_add_(0, seg, src)
def _pad(x, pw):
    flat = tuple(v for pair in reversed(pw) for v in pair)
    return torch.nn.functional.pad(x, flat)

kernel_name = 'recurrent_scan__gqa_block_cached__dense_activation_gelu__decode'

def setup_inputs():

    _w = (lambda a: (lambda t: t.to(torch.bfloat16) if t.is_floating_point() else t)(torch.as_tensor(a)))
    def _A_setup():
        B, Sq, D = 2, 1, 512
        Hq, Hkv, Sk, Dh = 32, 8, 32768, 128
        assert Hq % Hkv == 0, (Hq, Hkv)
        return {
            "x": _w((lambda *s: torch.randn(*s, dtype=torch.bfloat16) * 0.1)(B, Sq, D)),
            "k_cache": _w((lambda *s: torch.randn(*s, dtype=torch.bfloat16) * 0.8)(B, Hkv, Sk, Dh)),
            "v_cache": _w((lambda *s: torch.randn(*s, dtype=torch.bfloat16) * 3.2)(B, Hkv, Sk, Dh)),
            "wq": _w((lambda *s: torch.randn(*s, dtype=torch.bfloat16) * 0.8)(D, Hq * Dh) * (D ** -0.5)),
            "wo": _w((lambda *s: torch.randn(*s, dtype=torch.bfloat16) * 3.2)(Hq * Dh, D) * ((Hq * Dh) ** -0.5)),
        }
    _A_in = _A_setup()

    def _B_setup():
        B, S, D, F = 2, 1, 512, 1792
        return {
            "x": _w((lambda *s: torch.randn(*s, dtype=torch.bfloat16) * 0.1)(B, S, D)),
            "w1": _w((lambda *s: torch.randn(*s, dtype=torch.bfloat16) * 3.2)(D, F) * (D ** -0.5)),
            "b1": _w((lambda *s: torch.randn(*s, dtype=torch.bfloat16) * 3.2)(F) * 0.01),
            "w2": _w((lambda *s: torch.randn(*s, dtype=torch.bfloat16) * 3.2)(F, D) * (F ** -0.5)),
            "b2": _w((lambda *s: torch.randn(*s, dtype=torch.bfloat16) * 3.2)(D) * 0.01),
        }
    _B_in = _B_setup()

    return {
        "A_x": _A_in["x"],
        "A_k_cache": _A_in["k_cache"],
        "A_v_cache": _A_in["v_cache"],
        "A_wq": _A_in["wq"],
        "A_wo": _A_in["wo"],
        "B_x": _B_in["x"],
        "B_w1": _B_in["w1"],
        "B_b1": _B_in["b1"],
        "B_w2": _B_in["w2"],
        "B_b2": _B_in["b2"],
    }

def reference(A_x, A_k_cache, A_v_cache, A_wq, A_wo, B_x, B_w1, B_b1, B_w2, B_b2):
    def _A_ref(x, k_cache, v_cache, wq, wo):
        B, Sq, D = x.shape
        Hq, Dh = 32, 128
        Hkv = k_cache.shape[1]
        rep = Hq // Hkv
        q = (lambda x, *d: x.permute(*d))((x @ wq).reshape(B, Sq, Hq, Dh), 0, 2, 1, 3)
        k = (lambda x, n, axis: torch.repeat_interleave(x, n, dim=axis))(k_cache, rep, axis=1)
        v = (lambda x, n, axis: torch.repeat_interleave(x, n, dim=axis))(v_cache, rep, axis=1)
        scores = torch.einsum("bhqd,bhkd->bhqk", q, k) * (Dh ** -0.5)
        p = _softmax(scores, axis=-1)
        o = torch.einsum("bhqk,bhkd->bhqd", p, v)
        return (lambda x, *d: x.permute(*d))(o, 0, 2, 1, 3).reshape(B, Sq, Hq * Dh) @ wo

    def _B_ref(x, w1, b1, w2, b2):
        h = torch.einsum("bsd,df->bsf", x, w1) + b1
        h = _gelu(h)
        return torch.einsum("bsf,fd->bsd", h, w2) + b2

    x = A_x
    xn = _layernorm(x, axis=-1)
    s = _A_ref(xn, A_k_cache, A_v_cache, A_wq, A_wo)
    g = _silu(_B_ref(xn, B_w1, B_b1, B_w2, B_b2))
    return x + s * g
```

```asm
; @launch grid=(256,1,1) block=(320,1,1) lds=151552
.amdgcn_target "amdgcn-amd-amdhsa--gfx950"
.text
.globl recurrent_scan__gqa_block_cached__dense_activation_gelu__decode_kernel
.p2align 8
.type recurrent_scan__gqa_block_cached__dense_activation_gelu__decode_kernel,@function
recurrent_scan__gqa_block_cached__dense_activation_gelu__decode_kernel:
  s_cmp_ge_u32 s2, 256
  s_cbranch_scc1 L_exit
  s_load_dwordx16 s[4:19], s[0:1], 0
  s_load_dwordx8 s[20:27], s[0:1], 64
  s_load_dwordx2 s[28:29], s[0:1], 96
  v_lshrrev_b32 v2, 6, v0
  v_and_b32 v1, 63, v0
  v_readfirstlane_b32 s3, v2
  s_lshr_b32 s97, s2, 3
  s_cmp_eq_u32 s3, 0
  s_cbranch_scc1 L_helper
  s_sub_u32 s3, s3, 1
  v_subrev_u32 v0, 64, v0
  s_cmp_ge_u32 s3, 2
  s_cbranch_scc1 L_nopf
  s_getpc_b64 s[30:31]
L_pc:
  s_sub_u32 s30, s30, L_pc-recurrent_scan__gqa_block_cached__dense_activation_gelu__decode_kernel
  s_subb_u32 s31, s31, 0
  s_lshl_b32 s74, s3, 5
  s_add_u32 s73, s97, s74
  s_lshl_b32 s73, s73, 10
  v_lshl_add_u32 v22, v1, 4, s73
  v_min_u32 v22, L_codeend-recurrent_scan__gqa_block_cached__dense_activation_gelu__decode_kernel-16, v22
  global_load_dwordx4 v[252:255], v22, s[30:31]
L_nopf:
  v_lshrrev_b32 v26, 3, v1
  v_lshlrev_b32 v26, 13, v26
  v_bfe_u32 v27, v1, 4, 2
  v_lshlrev_b32 v27, 1, v27
  v_and_b32 v25, 7, v1
  v_xor_b32 v25, v25, v27
  v_lshl_add_u32 v25, v25, 4, v26
  s_lshr_b32 s75, s2, 2
  s_lshl_b32 s75, s75, 7
  s_and_b32 s76, s2, 3
  s_lshl_b32 s76, s76, 20
  s_add_u32 s75, s75, s76
  s_lshl_b32 s76, s3, 18
  s_add_u32 s75, s75, s76
  v_add_u32 v25, s75, v25
  s_lshl_b32 s78, s3, 12
  s_add_u32 s78, s78, 131072
  v_lshrrev_b32 v22, 4, v1
  v_and_b32 v23, 15, v1
  s_lshl_b32 s73, s3, 12
  s_lshl_b32 s64, s3, 15
  v_lshlrev_b32 v24, 8, v22
  v_add_u32 v24, s73, v24
  v_add_u32 v26, 0, v22
  v_xor_b32 v26, v26, v23
  v_lshl_add_u32 v2, v26, 4, v24
  v_add_u32 v26, 4, v22
  v_xor_b32 v26, v26, v23
  v_lshl_add_u32 v3, v26, 4, v24
  v_add_u32 v26, 8, v22
  v_xor_b32 v26, v26, v23
  v_lshl_add_u32 v4, v26, 4, v24
  v_add_u32 v26, 12, v22
  v_xor_b32 v26, v26, v23
  v_lshl_add_u32 v5, v26, 4, v24
  s_waitcnt lgkmcnt(0)
  s_lshl_b32 s74, s2, 19
  s_mov_b32 s48, s10
  s_and_b32 s49, s11, 0xffff
  s_mov_b32 s50, 0x400000
  s_mov_b32 s51, 0x20000
  s_add_u32 m0, s78, 0
  s_mov_b32 s77, 0
  buffer_load_dwordx4 v25, s[48:51], s77 offen nt lds
  s_add_u32 m0, s78, 1024
  s_mov_b32 s77, 65536
  buffer_load_dwordx4 v25, s[48:51], s77 offen nt lds
  s_add_u32 m0, s78, 2048
  s_mov_b32 s77, 131072
  buffer_load_dwordx4 v25, s[48:51], s77 offen nt lds
  s_add_u32 m0, s78, 3072
  s_mov_b32 s77, 196608
  buffer_load_dwordx4 v25, s[48:51], s77 offen nt lds
  s_add_u32 s32, s6, s74
  s_addc_u32 s33, s7, 0
  s_and_b32 s33, s33, 0xffff
  s_mov_b32 s34, 0x80000
  s_mov_b32 s35, 0x20000
  s_add_u32 m0, s64, 0
  s_mov_b32 s65, 0
  buffer_load_dwordx4 v2, s[32:35], s65 offen offset:0 nt lds
  buffer_load_dwordx4 v3, s[32:35], s65 offen offset:1024 nt lds
  buffer_load_dwordx4 v4, s[32:35], s65 offen offset:2048 nt lds
  buffer_load_dwordx4 v5, s[32:35], s65 offen offset:3072 nt lds
  s_add_u32 m0, s64, 4096
  s_mov_b32 s65, 16384
  buffer_load_dwordx4 v2, s[32:35], s65 offen offset:0 nt lds
  buffer_load_dwordx4 v3, s[32:35], s65 offen offset:1024 nt lds
  buffer_load_dwordx4 v4, s[32:35], s65 offen offset:2048 nt lds
  buffer_load_dwordx4 v5, s[32:35], s65 offen offset:3072 nt lds
  s_add_u32 s36, s8, s74
  s_addc_u32 s37, s9, 0
  s_and_b32 s37, s37, 0xffff
  s_mov_b32 s38, 0x80000
  s_mov_b32 s39, 0x20000
  s_mov_b32 s44, s28
  s_and_b32 s45, s29, 0xffff
  s_mov_b32 s46, 0x200000
  s_mov_b32 s47, 0x20000
  s_mov_b32 s40, s12
  s_and_b32 s41, s13, 0xffff
  s_mov_b32 s42, 0x400000
  s_mov_b32 s43, 0x20000
  v_lshlrev_b32 v25, 1, v22
  v_add_u32 v25, 0, v25
  v_xor_b32 v25, v25, v23
  v_lshl_add_u32 v6, v25, 4, v24
  v_lshlrev_b32 v25, 1, v22
  v_add_u32 v25, 8, v25
  v_xor_b32 v25, v25, v23
  v_lshl_add_u32 v7, v25, 4, v24
  v_lshlrev_b32 v26, 8, v23
  v_add_u32 v26, s64, v26
  v_add_u32 v25, 0, v22
  v_xor_b32 v25, v25, v23
  v_lshl_add_u32 v8, v25, 4, v26
  v_add_u32 v25, 4, v22
  v_xor_b32 v25, v25, v23
  v_lshl_add_u32 v9, v25, 4, v26
  v_add_u32 v25, 8, v22
  v_xor_b32 v25, v25, v23
  v_lshl_add_u32 v10, v25, 4, v26
  v_add_u32 v25, 12, v22
  v_xor_b32 v25, v25, v23
  v_lshl_add_u32 v11, v25, 4, v26
  v_lshrrev_b32 v27, 2, v1
  v_lshlrev_b32 v26, 8, v27
  v_add_u32 v26, s64, v26
  v_and_b32 v28, 1, v1
  v_lshl_add_u32 v26, v28, 3, v26
  v_and_b32 v27, 7, v27
  v_lshlrev_b32 v27, 1, v27
  v_bfe_u32 v28, v1, 1, 1
  v_add_u32 v25, 0, v28
  v_xor_b32 v25, v25, v27
  v_lshl_add_u32 v12, v25, 4, v26
  v_add_u32 v25, 2, v28
  v_xor_b32 v25, v25, v27
  v_lshl_add_u32 v13, v25, 4, v26
  v_add_u32 v25, 4, v28
  v_xor_b32 v25, v25, v27
  v_lshl_add_u32 v14, v25, 4, v26
  v_add_u32 v25, 6, v28
  v_xor_b32 v25, v25, v27
  v_lshl_add_u32 v15, v25, 4, v26
  v_add_u32 v25, 8, v28
  v_xor_b32 v25, v25, v27
  v_lshl_add_u32 v16, v25, 4, v26
  v_add_u32 v25, 10, v28
  v_xor_b32 v25, v25, v27
  v_lshl_add_u32 v17, v25, 4, v26
  v_add_u32 v25, 12, v28
  v_xor_b32 v25, v25, v27
  v_lshl_add_u32 v18, v25, 4, v26
  v_add_u32 v25, 14, v28
  v_xor_b32 v25, v25, v27
  v_lshl_add_u32 v19, v25, 4, v26
  s_lshr_b32 s67, s2, 4
  s_and_b32 s68, s2, 15
  s_movk_i32 s71, 1023
  s_mov_b32 s69, 1
  s_cmp_eq_u32 s3, 3
  s_cselect_b32 s98, 1, 0
  s_and_b32 s75, s67, 7
  s_lshl_b32 s75, s75, 19
  s_lshl_b32 s76, s68, 13
  s_add_u32 s75, s75, s76
  s_lshl_b32 s76, s3, 8
  s_add_u32 s75, s75, s76
  v_lshrrev_b32 v20, 5, v1
  v_lshlrev_b32 v20, 18, v20
  v_and_b32 v25, 31, v1
  v_lshl_add_u32 v20, v25, 3, v20
  v_add_u32 v20, s75, v20
  s_setprio 1
  s_waitcnt vmcnt(8)
  s_barrier
  v_mov_b32 v32, 0
  v_mov_b32 v33, 0
  v_mov_b32 v34, 0
  v_mov_b32 v35, 0
  v_mov_b32 v36, 0
  v_mov_b32 v37, 0
  v_mov_b32 v38, 0
  v_mov_b32 v39, 0
  v_mov_b32 v40, 0
  v_mov_b32 v41, 0
  v_mov_b32 v42, 0
  v_mov_b32 v43, 0
  v_mov_b32 v44, 0
  v_mov_b32 v45, 0
  v_mov_b32 v46, 0
  v_mov_b32 v47, 0
  v_mov_b32 v48, 0
  v_mov_b32 v49, 0
  v_mov_b32 v50, 0
  v_mov_b32 v51, 0
  v_mov_b32 v52, 0
  v_mov_b32 v53, 0
  v_mov_b32 v54, 0
  v_mov_b32 v55, 0
  v_mov_b32 v56, 0
  v_mov_b32 v57, 0
  v_mov_b32 v58, 0
  v_mov_b32 v59, 0
  v_mov_b32 v60, 0
  v_mov_b32 v61, 0
  v_mov_b32 v62, 0
  v_mov_b32 v63, 0
  v_mov_b32 v64, 0
  v_mov_b32 v65, 0
  v_mov_b32 v66, 0
  v_mov_b32 v67, 0
  v_mov_b32 v68, 0
  v_mov_b32 v69, 0
  v_mov_b32 v70, 0
  v_mov_b32 v71, 0
  v_mov_b32 v72, 0
  v_mov_b32 v73, 0
  v_mov_b32 v74, 0
  v_mov_b32 v75, 0
  v_mov_b32 v76, 0
  v_mov_b32 v77, 0
  v_mov_b32 v78, 0
  v_mov_b32 v79, 0
  v_mov_b32 v80, 0
  v_mov_b32 v81, 0
  v_mov_b32 v82, 0
  v_mov_b32 v83, 0
  v_mov_b32 v84, 0
  v_mov_b32 v85, 0
  v_mov_b32 v86, 0
  v_mov_b32 v87, 0
  v_mov_b32 v88, 0
  v_mov_b32 v89, 0
  v_mov_b32 v90, 0
  v_mov_b32 v91, 0
  v_mov_b32 v92, 0
  v_mov_b32 v93, 0
  v_mov_b32 v94, 0
  v_mov_b32 v95, 0
  v_mov_b32 v254, 151088
  v_mov_b32 v255, 151096
  s_waitcnt vmcnt(5)
  s_add_u32 m0, s64, 8192
  s_mov_b32 s65, 32768
  buffer_load_dwordx4 v2, s[32:35], s65 offen offset:0 nt lds
  s_waitcnt vmcnt(5)
  buffer_load_dwordx4 v3, s[32:35], s65 offen offset:1024 nt lds
  s_waitcnt vmcnt(5)
  buffer_load_dwordx4 v4, s[32:35], s65 offen offset:2048 nt lds
  s_waitcnt vmcnt(5)
  buffer_load_dwordx4 v5, s[32:35], s65 offen offset:3072 nt lds
  s_waitcnt vmcnt(5)
  s_add_u32 m0, s64, 12288
  s_mov_b32 s65, 49152
  buffer_load_dwordx4 v2, s[32:35], s65 offen offset:0 nt lds
  s_waitcnt vmcnt(5)
  buffer_load_dwordx4 v3, s[32:35], s65 offen offset:1024 nt lds
  s_waitcnt vmcnt(5)
  buffer_load_dwordx4 v4, s[32:35], s65 offen offset:2048 nt lds
  s_waitcnt vmcnt(5)
  buffer_load_dwordx4 v5, s[32:35], s65 offen offset:3072 nt lds
  s_waitcnt vmcnt(5)
  s_add_u32 m0, s64, 16384
  s_mov_b32 s65, 65536
  buffer_load_dwordx4 v2, s[32:35], s65 offen offset:0 nt lds
  s_waitcnt vmcnt(5)
  buffer_load_dwordx4 v3, s[32:35], s65 offen offset:1024 nt lds
  s_waitcnt vmcnt(5)
  buffer_load_dwordx4 v4, s[32:35], s65 offen offset:2048 nt lds
  s_waitcnt vmcnt(5)
  buffer_load_dwordx4 v5, s[32:35], s65 offen offset:3072 nt lds
  s_waitcnt vmcnt(5)
  s_add_u32 m0, s64, 20480
  s_mov_b32 s65, 81920
  buffer_load_dwordx4 v2, s[32:35], s65 offen offset:0 nt lds
  s_waitcnt vmcnt(5)
  buffer_load_dwordx4 v3, s[32:35], s65 offen offset:1024 nt lds
  s_waitcnt vmcnt(5)
  buffer_load_dwordx4 v4, s[32:35], s65 offen offset:2048 nt lds
  s_waitcnt vmcnt(5)
  buffer_load_dwordx4 v5, s[32:35], s65 offen offset:3072 nt lds
  s_waitcnt vmcnt(5)
  s_add_u32 m0, s64, 24576
  s_mov_b32 s65, 98304
  buffer_load_dwordx4 v2, s[32:35], s65 offen offset:0 nt lds
  s_waitcnt vmcnt(5)
  buffer_load_dwordx4 v3, s[32:35], s65 offen offset:1024 nt lds
  s_waitcnt vmcnt(5)
  buffer_load_dwordx4 v4, s[32:35], s65 offen offset:2048 nt lds
  s_waitcnt vmcnt(5)
  buffer_load_dwordx4 v5, s[32:35], s65 offen offset:3072 nt lds
  s_waitcnt vmcnt(5)
  s_add_u32 m0, s64, 28672
  s_mov_b32 s65, 114688
  buffer_load_dwordx4 v2, s[32:35], s65 offen offset:0 nt lds
  s_waitcnt vmcnt(5)
  buffer_load_dwordx4 v3, s[32:35], s65 offen offset:1024 nt lds
  s_waitcnt vmcnt(5)
  buffer_load_dwordx4 v4, s[32:35], s65 offen offset:2048 nt lds
  s_waitcnt vmcnt(5)
  buffer_load_dwordx4 v5, s[32:35], s65 offen offset:3072 nt lds
  v_mov_b32 v25, 151048
  s_mov_b32 s70, 1920000
L_qfwait:
  ds_read_b32 v26, v25
  s_waitcnt lgkmcnt(0)
  v_readfirstlane_b32 s79, v26
  s_nop 0
  s_cmp_lg_u32 s79, 0
  s_cbranch_scc1 L_qfok
  s_sub_u32 s70, s70, 1
  s_cmp_lg_u32 s70, 0
  s_cbranch_scc0 L_qfok
  s_sleep 1
  s_branch L_qfwait
L_qfok:
  v_and_b32 v25, 3, v1
  v_lshlrev_b32 v25, 8, v25
  v_lshl_add_u32 v25, v22, 4, v25
  v_add_u32 v25, 149504, v25
  v_mov_b32 v26, 150528
  ds_read_b32 v252, v26
  s_mov_b32 exec_lo, 0xf000f
  s_mov_b32 exec_hi, 0xf000f
  ds_read_b128 v[32:35], v25 offset:0
  ds_read_b128 v[36:39], v25 offset:64
  ds_read_b128 v[40:43], v25 offset:128
  ds_read_b128 v[44:47], v25 offset:192
  s_mov_b32 exec_lo, 0xf000f0
  s_mov_b32 exec_hi, 0xf000f0
  ds_read_b128 v[48:51], v25 offset:0
  ds_read_b128 v[52:55], v25 offset:64
  ds_read_b128 v[56:59], v25 offset:128
  ds_read_b128 v[60:63], v25 offset:192
  s_waitcnt lgkmcnt(4)
  s_mov_b32 exec_lo, 0xf000f00
  s_mov_b32 exec_hi, 0xf000f00
  ds_read_b128 v[64:67], v25 offset:0
  ds_read_b128 v[68:71], v25 offset:64
  ds_read_b128 v[72:75], v25 offset:128
  ds_read_b128 v[76:79], v25 offset:192
  s_mov_b32 exec_lo, 0xf000f000
  s_mov_b32 exec_hi, 0xf000f000
  ds_read_b128 v[80:83], v25 offset:0
  ds_read_b128 v[84:87], v25 offset:64
  ds_read_b128 v[88:91], v25 offset:128
  ds_read_b128 v[92:95], v25 offset:192
  s_mov_b64 exec, -1
  s_waitcnt lgkmcnt(0)
  v_readfirstlane_b32 s66, v252
  s_nop 0
  s_and_b32 s66, s66, 1023
  ds_read_b128 v[144:147], v8 offset:0
  ds_read_b128 v[148:151], v9 offset:0
  ds_read_b128 v[152:155], v10 offset:0
  ds_read_b128 v[156:159], v11 offset:0
  s_waitcnt lgkmcnt(3)
  v_mfma_f32_16x16x32_bf16 v[96:99], v[144:147], v[32:35], 0
  s_waitcnt lgkmcnt(2)
  v_mfma_f32_16x16x32_bf16 v[96:99], v[148:151], v[36:39], v[96:99]
  s_waitcnt lgkmcnt(1)
  v_mfma_f32_16x16x32_bf16 v[96:99], v[152:155], v[40:43], v[96:99]
  s_waitcnt lgkmcnt(0)
  v_mfma_f32_16x16x32_bf16 v[96:99], v[156:159], v[44:47], v[96:99]
  s_waitcnt vmcnt(5)
  s_add_u32 m0, s64, 0
  s_mov_b32 s65, 131072
  buffer_load_dwordx4 v2, s[32:35], s65 offen offset:0 nt lds
  s_waitcnt vmcnt(5)
  buffer_load_dwordx4 v3, s[32:35], s65 offen offset:1024 nt lds
  ds_read_b128 v[160:163], v8 offset:4096
  ds_read_b128 v[164:167], v9 offset:4096
  ds_read_b128 v[168:171], v10 offset:4096
  ds_read_b128 v[172:175], v11 offset:4096
  s_waitcnt lgkmcnt(3)
  v_mfma_f32_16x16x32_bf16 v[100:103], v[160:163], v[32:35], 0
  s_waitcnt lgkmcnt(2)
  v_mfma_f32_16x16x32_bf16 v[100:103], v[164:167], v[36:39], v[100:103]
  s_waitcnt lgkmcnt(1)
  v_mfma_f32_16x16x32_bf16 v[100:103], v[168:171], v[40:43], v[100:103]
  s_waitcnt lgkmcnt(0)
  v_mfma_f32_16x16x32_bf16 v[100:103], v[172:175], v[44:47], v[100:103]
  s_waitcnt vmcnt(5)
  buffer_load_dwordx4 v4, s[32:35], s65 offen offset:2048 nt lds
  s_waitcnt vmcnt(5)
  buffer_load_dwordx4 v5, s[32:35], s65 offen offset:3072 nt lds
  ds_read_b128 v[144:147], v8 offset:8192
  ds_read_b128 v[148:151], v9 offset:8192
  ds_read_b128 v[152:155], v10 offset:8192
  ds_read_b128 v[156:159], v11 offset:8192
  s_waitcnt lgkmcnt(3)
  v_mfma_f32_16x16x32_bf16 v[96:99], v[144:147], v[48:51], v[96:99]
  s_waitcnt lgkmcnt(2)
  v_mfma_f32_16x16x32_bf16 v[96:99], v[148:151], v[52:55], v[96:99]
  s_waitcnt lgkmcnt(1)
  v_mfma_f32_16x16x32_bf16 v[96:99], v[152:155], v[56:59], v[96:99]
  s_waitcnt lgkmcnt(0)
  v_mfma_f32_16x16x32_bf16 v[96:99], v[156:159], v[60:63], v[96:99]
  s_waitcnt vmcnt(5)
  s_add_u32 m0, s64, 4096
  s_mov_b32 s65, 147456
  buffer_load_dwordx4 v2, s[32:35], s65 offen offset:0 nt lds
  s_waitcnt vmcnt(5)
  buffer_load_dwordx4 v3, s[32:35], s65 offen offset:1024 nt lds
  ds_read_b128 v[160:163], v8 offset:12288
  ds_read_b128 v[164:167], v9 offset:12288
  ds_read_b128 v[168:171], v10 offset:12288
  ds_read_b128 v[172:175], v11 offset:12288
  s_waitcnt lgkmcnt(3)
  v_mfma_f32_16x16x32_bf16 v[100:103], v[160:163], v[48:51], v[100:103]
  s_waitcnt lgkmcnt(2)
  v_mfma_f32_16x16x32_bf16 v[100:103], v[164:167], v[52:55], v[100:103]
  s_waitcnt lgkmcnt(1)
  v_mfma_f32_16x16x32_bf16 v[100:103], v[168:171], v[56:59], v[100:103]
  s_waitcnt lgkmcnt(0)
  v_mfma_f32_16x16x32_bf16 v[100:103], v[172:175], v[60:63], v[100:103]
  s_waitcnt vmcnt(5)
  buffer_load_dwordx4 v4, s[32:35], s65 offen offset:2048 nt lds
  s_waitcnt vmcnt(5)
  buffer_load_dwordx4 v5, s[32:35], s65 offen offset:3072 nt lds
  ds_read_b128 v[144:147], v8 offset:16384
  ds_read_b128 v[148:151], v9 offset:16384
  ds_read_b128 v[152:155], v10 offset:16384
  ds_read_b128 v[156:159], v11 offset:16384
  s_waitcnt lgkmcnt(3)
  v_mfma_f32_16x16x32_bf16 v[96:99], v[144:147], v[64:67], v[96:99]
  s_waitcnt lgkmcnt(2)
  v_mfma_f32_16x16x32_bf16 v[96:99], v[148:151], v[68:71], v[96:99]
  s_waitcnt lgkmcnt(1)
  v_mfma_f32_16x16x32_bf16 v[96:99], v[152:155], v[72:75], v[96:99]
  s_waitcnt lgkmcnt(0)
  v_mfma_f32_16x16x32_bf16 v[96:99], v[156:159], v[76:79], v[96:99]
  s_waitcnt vmcnt(5)
  s_add_u32 m0, s64, 8192
  s_mov_b32 s65, 163840
  buffer_load_dwordx4 v2, s[32:35], s65 offen offset:0 nt lds
  s_waitcnt vmcnt(5)
  buffer_load_dwordx4 v3, s[32:35], s65 offen offset:1024 nt lds
  ds_read_b128 v[160:163], v8 offset:20480
  ds_read_b128 v[164:167], v9 offset:20480
  ds_read_b128 v[168:171], v10 offset:20480
  ds_read_b128 v[172:175], v11 offset:20480
  s_waitcnt lgkmcnt(3)
  v_mfma_f32_16x16x32_bf16 v[100:103], v[160:163], v[64:67], v[100:103]
  s_waitcnt lgkmcnt(2)
  v_mfma_f32_16x16x32_bf16 v[100:103], v[164:167], v[68:71], v[100:103]
  s_waitcnt lgkmcnt(1)
  v_mfma_f32_16x16x32_bf16 v[100:103], v[168:171], v[72:75], v[100:103]
  s_waitcnt lgkmcnt(0)
  v_mfma_f32_16x16x32_bf16 v[100:103], v[172:175], v[76:79], v[100:103]
  s_waitcnt vmcnt(5)
  buffer_load_dwordx4 v4, s[32:35], s65 offen offset:2048 nt lds
  s_waitcnt vmcnt(5)
  buffer_load_dwordx4 v5, s[32:35], s65 offen offset:3072 nt lds
  ds_read_b128 v[144:147], v8 offset:24576
  ds_read_b128 v[148:151], v9 offset:24576
  ds_read_b128 v[152:155], v10 offset:24576
  ds_read_b128 v[156:159], v11 offset:24576
  s_waitcnt lgkmcnt(3)
  v_mfma_f32_16x16x32_bf16 v[96:99], v[144:147], v[80:83], v[96:99]
  s_waitcnt lgkmcnt(2)
  v_mfma_f32_16x16x32_bf16 v[96:99], v[148:151], v[84:87], v[96:99]
  s_waitcnt lgkmcnt(1)
  v_mfma_f32_16x16x32_bf16 v[96:99], v[152:155], v[88:91], v[96:99]
  s_waitcnt lgkmcnt(0)
  v_mfma_f32_16x16x32_bf16 v[96:99], v[156:159], v[92:95], v[96:99]
  s_waitcnt vmcnt(5)
  s_add_u32 m0, s64, 12288
  s_mov_b32 s65, 180224
  buffer_load_dwordx4 v2, s[32:35], s65 offen offset:0 nt lds
  s_waitcnt vmcnt(5)
  buffer_load_dwordx4 v3, s[32:35], s65 offen offset:1024 nt lds
  ds_read_b128 v[160:163], v8 offset:28672
  ds_read_b128 v[164:167], v9 offset:28672
  ds_read_b128 v[168:171], v10 offset:28672
  ds_read_b128 v[172:175], v11 offset:28672
  s_waitcnt lgkmcnt(3)
  v_mfma_f32_16x16x32_bf16 v[100:103], v[160:163], v[80:83], v[100:103]
  s_waitcnt lgkmcnt(2)
  v_mfma_f32_16x16x32_bf16 v[100:103], v[164:167], v[84:87], v[100:103]
  s_waitcnt lgkmcnt(1)
  v_mfma_f32_16x16x32_bf16 v[100:103], v[168:171], v[88:91], v[100:103]
  s_waitcnt lgkmcnt(0)
  v_mfma_f32_16x16x32_bf16 v[100:103], v[172:175], v[92:95], v[100:103]
  s_waitcnt vmcnt(5)
  buffer_load_dwordx4 v4, s[32:35], s65 offen offset:2048 nt lds
  s_waitcnt vmcnt(5)
  buffer_load_dwordx4 v5, s[32:35], s65 offen offset:3072 nt lds
  ds_read_b128 v[144:147], v8 offset:0
  ds_read_b128 v[148:151], v9 offset:0
  ds_read_b128 v[152:155], v10 offset:0
  ds_read_b128 v[156:159], v11 offset:0
  s_waitcnt lgkmcnt(3)
  v_mfma_f32_16x16x32_bf16 v[104:107], v[144:147], v[32:35], 0
  s_waitcnt lgkmcnt(2)
  v_mfma_f32_16x16x32_bf16 v[104:107], v[148:151], v[36:39], v[104:107]
  s_waitcnt lgkmcnt(1)
  v_mfma_f32_16x16x32_bf16 v[104:107], v[152:155], v[40:43], v[104:107]
  s_waitcnt lgkmcnt(0)
  v_mfma_f32_16x16x32_bf16 v[104:107], v[156:159], v[44:47], v[104:107]
  s_waitcnt vmcnt(5)
  s_add_u32 m0, s64, 16384
  s_mov_b32 s65, 196608
  buffer_load_dwordx4 v2, s[32:35], s65 offen offset:0 nt lds
  s_waitcnt vmcnt(5)
  buffer_load_dwordx4 v3, s[32:35], s65 offen offset:1024 nt lds
  ds_read_b128 v[160:163], v8 offset:4096
  ds_read_b128 v[164:167], v9 offset:4096
  ds_read_b128 v[168:171], v10 offset:4096
  ds_read_b128 v[172:175], v11 offset:4096
  s_waitcnt lgkmcnt(3)
  v_mfma_f32_16x16x32_bf16 v[108:111], v[160:163], v[32:35], 0
  s_waitcnt lgkmcnt(2)
  v_mfma_f32_16x16x32_bf16 v[108:111], v[164:167], v[36:39], v[108:111]
  s_waitcnt lgkmcnt(1)
  v_mfma_f32_16x16x32_bf16 v[108:111], v[168:171], v[40:43], v[108:111]
  s_waitcnt lgkmcnt(0)
  v_mfma_f32_16x16x32_bf16 v[108:111], v[172:175], v[44:47], v[108:111]
  s_waitcnt vmcnt(5)
  buffer_load_dwordx4 v4, s[32:35], s65 offen offset:2048 nt lds
  s_waitcnt vmcnt(5)
  buffer_load_dwordx4 v5, s[32:35], s65 offen offset:3072 nt lds
  ds_read_b128 v[144:147], v8 offset:8192
  ds_read_b128 v[148:151], v9 offset:8192
  ds_read_b128 v[152:155], v10 offset:8192
  ds_read_b128 v[156:159], v11 offset:8192
  s_waitcnt lgkmcnt(3)
  v_mfma_f32_16x16x32_bf16 v[104:107], v[144:147], v[48:51], v[104:107]
  s_waitcnt lgkmcnt(2)
  v_mfma_f32_16x16x32_bf16 v[104:107], v[148:151], v[52:55], v[104:107]
  s_waitcnt lgkmcnt(1)
  v_mfma_f32_16x16x32_bf16 v[104:107], v[152:155], v[56:59], v[104:107]
  s_waitcnt lgkmcnt(0)
  v_mfma_f32_16x16x32_bf16 v[104:107], v[156:159], v[60:63], v[104:107]
  s_waitcnt vmcnt(5)
  s_add_u32 m0, s64, 20480
  s_mov_b32 s65, 212992
  buffer_load_dwordx4 v2, s[32:35], s65 offen offset:0 nt lds
  s_waitcnt vmcnt(5)
  ds_read_b128 v[160:163], v8 offset:12288
  ds_read_b128 v[164:167], v9 offset:12288
  ds_read_b128 v[168:171], v10 offset:12288
  ds_read_b128 v[172:175], v11 offset:12288
  s_waitcnt lgkmcnt(3)
  v_mfma_f32_16x16x32_bf16 v[108:111], v[160:163], v[48:51], v[108:111]
  s_waitcnt lgkmcnt(2)
  v_mfma_f32_16x16x32_bf16 v[108:111], v[164:167], v[52:55], v[108:111]
  s_waitcnt lgkmcnt(1)
  v_mfma_f32_16x16x32_bf16 v[108:111], v[168:171], v[56:59], v[108:111]
  s_waitcnt lgkmcnt(0)
  v_mfma_f32_16x16x32_bf16 v[108:111], v[172:175], v[60:63], v[108:111]
  buffer_load_dwordx4 v3, s[32:35], s65 offen offset:1024 nt lds
  s_waitcnt vmcnt(5)
  buffer_load_dwordx4 v4, s[32:35], s65 offen offset:2048 nt lds
  s_waitcnt vmcnt(5)
  buffer_load_dwordx4 v5, s[32:35], s65 offen offset:3072 nt lds
  s_waitcnt vmcnt(5)
  s_add_u32 m0, s64, 24576
  s_mov_b32 s65, 229376
  buffer_load_dwordx4 v2, s[32:35], s65 offen offset:0 nt lds
  s_waitcnt vmcnt(5)
  ds_read_b128 v[144:147], v8 offset:16384
  ds_read_b128 v[148:151], v9 offset:16384
  ds_read_b128 v[152:155], v10 offset:16384
  ds_read_b128 v[156:159], v11 offset:16384
  s_waitcnt lgkmcnt(3)
  v_mfma_f32_16x16x32_bf16 v[104:107], v[144:147], v[64:67], v[104:107]
  s_waitcnt lgkmcnt(2)
  v_mfma_f32_16x16x32_bf16 v[104:107], v[148:151], v[68:71], v[104:107]
  s_waitcnt lgkmcnt(1)
  v_mfma_f32_16x16x32_bf16 v[104:107], v[152:155], v[72:75], v[104:107]
  s_waitcnt lgkmcnt(0)
  v_mfma_f32_16x16x32_bf16 v[104:107], v[156:159], v[76:79], v[104:107]
  buffer_load_dwordx4 v3, s[32:35], s65 offen offset:1024 nt lds
  s_waitcnt vmcnt(5)
  buffer_load_dwordx4 v4, s[32:35], s65 offen offset:2048 nt lds
  s_waitcnt vmcnt(5)
  buffer_load_dwordx4 v5, s[32:35], s65 offen offset:3072 nt lds
  s_waitcnt vmcnt(5)
  s_add_u32 m0, s64, 28672
  s_mov_b32 s65, 245760
  buffer_load_dwordx4 v2, s[32:35], s65 offen offset:0 nt lds
  s_waitcnt vmcnt(5)
  ds_read_b128 v[160:163], v8 offset:20480
  ds_read_b128 v[164:167], v9 offset:20480
  ds_read_b128 v[168:171], v10 offset:20480
  ds_read_b128 v[172:175], v11 offset:20480
  s_waitcnt lgkmcnt(3)
  v_mfma_f32_16x16x32_bf16 v[108:111], v[160:163], v[64:67], v[108:111]
  s_waitcnt lgkmcnt(2)
  v_mfma_f32_16x16x32_bf16 v[108:111], v[164:167], v[68:71], v[108:111]
  s_waitcnt lgkmcnt(1)
  v_mfma_f32_16x16x32_bf16 v[108:111], v[168:171], v[72:75], v[108:111]
  s_waitcnt lgkmcnt(0)
  v_mfma_f32_16x16x32_bf16 v[108:111], v[172:175], v[76:79], v[108:111]
  buffer_load_dwordx4 v3, s[32:35], s65 offen offset:1024 nt lds
  s_waitcnt vmcnt(5)
  buffer_load_dwordx4 v4, s[32:35], s65 offen offset:2048 nt lds
  s_waitcnt vmcnt(5)
  buffer_load_dwordx4 v5, s[32:35], s65 offen offset:3072 nt lds
  s_waitcnt vmcnt(5)
  s_add_u32 m0, s64, 0
  s_mov_b32 s65, 262144
  buffer_load_dwordx4 v2, s[32:35], s65 offen offset:0 nt lds
  s_waitcnt vmcnt(5)
  ds_read_b128 v[144:147], v8 offset:24576
  ds_read_b128 v[148:151], v9 offset:24576
  ds_read_b128 v[152:155], v10 offset:24576
  ds_read_b128 v[156:159], v11 offset:24576
  s_waitcnt lgkmcnt(3)
  v_mfma_f32_16x16x32_bf16 v[104:107], v[144:147], v[80:83], v[104:107]
  s_waitcnt lgkmcnt(2)
  v_mfma_f32_16x16x32_bf16 v[104:107], v[148:151], v[84:87], v[104:107]
  s_waitcnt lgkmcnt(1)
  v_mfma_f32_16x16x32_bf16 v[104:107], v[152:155], v[88:91], v[104:107]
  s_waitcnt lgkmcnt(0)
  v_mfma_f32_16x16x32_bf16 v[104:107], v[156:159], v[92:95], v[104:107]
  buffer_load_dwordx4 v3, s[32:35], s65 offen offset:1024 nt lds
  s_waitcnt vmcnt(5)
  buffer_load_dwordx4 v4, s[32:35], s65 offen offset:2048 nt lds
  s_waitcnt vmcnt(5)
  buffer_load_dwordx4 v5, s[32:35], s65 offen offset:3072 nt lds
  s_waitcnt vmcnt(5)
  s_add_u32 m0, s64, 4096
  s_mov_b32 s65, 278528
  buffer_load_dwordx4 v2, s[32:35], s65 offen offset:0 nt lds
  s_waitcnt vmcnt(5)
  ds_read_b128 v[160:163], v8 offset:28672
  ds_read_b128 v[164:167], v9 offset:28672
  ds_read_b128 v[168:171], v10 offset:28672
  ds_read_b128 v[172:175], v11 offset:28672
  s_waitcnt lgkmcnt(3)
  v_mfma_f32_16x16x32_bf16 v[108:111], v[160:163], v[80:83], v[108:111]
  s_waitcnt lgkmcnt(2)
  v_mfma_f32_16x16x32_bf16 v[108:111], v[164:167], v[84:87], v[108:111]
  s_waitcnt lgkmcnt(1)
  v_mfma_f32_16x16x32_bf16 v[108:111], v[168:171], v[88:91], v[108:111]
  s_waitcnt lgkmcnt(0)
  v_mfma_f32_16x16x32_bf16 v[108:111], v[172:175], v[92:95], v[108:111]
  buffer_load_dwordx4 v3, s[32:35], s65 offen offset:1024 nt lds
  s_waitcnt vmcnt(5)
  buffer_load_dwordx4 v4, s[32:35], s65 offen offset:2048 nt lds
  s_waitcnt vmcnt(5)
  buffer_load_dwordx4 v5, s[32:35], s65 offen offset:3072 nt lds
  ds_read_b32 v253, v254
  s_cmp_lg_u32 s3, 0
  s_cbranch_scc1 L_ck1
  s_memrealtime s[84:85]
  s_waitcnt lgkmcnt(0)
  v_mov_b32 v26, 1
  v_mov_b32 v27, s84
  s_mov_b64 exec, 1
  ds_write_b64 v255, v[26:27]
  s_mov_b64 exec, -1
L_ck1:
  s_waitcnt vmcnt(5)
  s_add_u32 m0, s64, 8192
  s_mov_b32 s65, 294912
  buffer_load_dwordx4 v2, s[32:35], s65 offen offset:0 nt lds
  s_waitcnt vmcnt(5)
  ds_read_b128 v[144:147], v8 offset:0
  ds_read_b128 v[148:151], v9 offset:0
  ds_read_b128 v[152:155], v10 offset:0
  ds_read_b128 v[156:159], v11 offset:0
  s_waitcnt lgkmcnt(3)
  v_mfma_f32_16x16x32_bf16 v[112:115], v[144:147], v[32:35], 0
  s_waitcnt lgkmcnt(2)
  v_mfma_f32_16x16x32_bf16 v[112:115], v[148:151], v[36:39], v[112:115]
  s_waitcnt lgkmcnt(1)
  v_mfma_f32_16x16x32_bf16 v[112:115], v[152:155], v[40:43], v[112:115]
  s_waitcnt lgkmcnt(0)
  v_mfma_f32_16x16x32_bf16 v[112:115], v[156:159], v[44:47], v[112:115]
  buffer_load_dwordx4 v3, s[32:35], s65 offen offset:1024 nt lds
  s_waitcnt vmcnt(5)
  buffer_load_dwordx4 v4, s[32:35], s65 offen offset:2048 nt lds
  s_waitcnt vmcnt(5)
  buffer_load_dwordx4 v5, s[32:35], s65 offen offset:3072 nt lds
  s_waitcnt vmcnt(5)
  s_add_u32 m0, s64, 12288
  s_mov_b32 s65, 311296
  buffer_load_dwordx4 v2, s[32:35], s65 offen offset:0 nt lds
  s_waitcnt vmcnt(5)
  ds_read_b128 v[160:163], v8 offset:4096
  ds_read_b128 v[164:167], v9 offset:4096
  ds_read_b128 v[168:171], v10 offset:4096
  ds_read_b128 v[172:175], v11 offset:4096
  s_waitcnt lgkmcnt(3)
  v_mfma_f32_16x16x32_bf16 v[116:119], v[160:163], v[32:35], 0
  s_waitcnt lgkmcnt(2)
  v_mfma_f32_16x16x32_bf16 v[116:119], v[164:167], v[36:39], v[116:119]
  s_waitcnt lgkmcnt(1)
  v_mfma_f32_16x16x32_bf16 v[116:119], v[168:171], v[40:43], v[116:119]
  s_waitcnt lgkmcnt(0)
  v_mfma_f32_16x16x32_bf16 v[116:119], v[172:175], v[44:47], v[116:119]
  buffer_load_dwordx4 v3, s[32:35], s65 offen offset:1024 nt lds
  s_waitcnt vmcnt(5)
  buffer_load_dwordx4 v4, s[32:35], s65 offen offset:2048 nt lds
  s_waitcnt vmcnt(5)
  buffer_load_dwordx4 v5, s[32:35], s65 offen offset:3072 nt lds
  s_cmp_ge_u32 s69, 2
  s_cbranch_scc1 L_ad2
  s_waitcnt vmcnt(5)
  s_cmp_ge_u32 s69, 1
  s_cbranch_scc1 L_ad2
  s_waitcnt vmcnt(4)
L_ad2:
  s_add_u32 m0, s64, 16384
  s_mov_b32 s65, 327680
  buffer_load_dwordx4 v2, s[32:35], s65 offen offset:0 nt lds
  s_waitcnt vmcnt(6)
  s_cmp_ge_u32 s69, 2
  s_cbranch_scc1 L_ad3
  s_waitcnt vmcnt(5)
  s_cmp_ge_u32 s69, 1
  s_cbranch_scc1 L_ad3
  s_waitcnt vmcnt(4)
L_ad3:
  buffer_load_dwordx4 v3, s[32:35], s65 offen offset:1024 nt lds
  s_waitcnt vmcnt(6)
  s_cmp_ge_u32 s69, 2
  s_cbranch_scc1 L_ad4
  s_waitcnt vmcnt(5)
  s_cmp_ge_u32 s69, 1
  s_cbranch_scc1 L_ad4
  s_waitcnt vmcnt(4)
L_ad4:
  buffer_load_dwordx4 v4, s[32:35], s65 offen offset:2048 nt lds
  s_waitcnt vmcnt(6)
  s_cmp_ge_u32 s69, 2
  s_cbranch_scc1 L_ad5
  s_waitcnt vmcnt(5)
  s_cmp_ge_u32 s69, 1
  s_cbranch_scc1 L_ad5
  s_waitcnt vmcnt(4)
L_ad5:
  buffer_load_dwordx4 v5, s[32:35], s65 offen offset:3072 nt lds
  v_readfirstlane_b32 s69, v253
  ds_read_b32 v253, v254
  s_waitcnt vmcnt(6)
  s_cmp_ge_u32 s69, 2
  s_cbranch_scc1 L_ad6
  s_waitcnt vmcnt(5)
  s_cmp_ge_u32 s69, 1
  s_cbranch_scc1 L_ad6
  s_waitcnt vmcnt(4)
L_ad6:
  s_add_u32 m0, s64, 20480
  s_mov_b32 s65, 344064
  buffer_load_dwordx4 v2, s[32:35], s65 offen offset:0 nt lds
  ds_read_b128 v[144:147], v8 offset:8192
  ds_read_b128 v[148:151], v9 offset:8192
  ds_read_b128 v[152:155], v10 offset:8192
  ds_read_b128 v[156:159], v11 offset:8192
  s_waitcnt lgkmcnt(3)
  v_mfma_f32_16x16x32_bf16 v[112:115], v[144:147], v[48:51], v[112:115]
  s_waitcnt lgkmcnt(2)
  v_mfma_f32_16x16x32_bf16 v[112:115], v[148:151], v[52:55], v[112:115]
  s_waitcnt lgkmcnt(1)
  v_mfma_f32_16x16x32_bf16 v[112:115], v[152:155], v[56:59], v[112:115]
  s_waitcnt lgkmcnt(0)
  v_mfma_f32_16x16x32_bf16 v[112:115], v[156:159], v[60:63], v[112:115]
  s_waitcnt vmcnt(6)
  s_cmp_ge_u32 s69, 2
  s_cbranch_scc1 L_ad7
  s_waitcnt vmcnt(5)
  s_cmp_ge_u32 s69, 1
  s_cbranch_scc1 L_ad7
  s_waitcnt vmcnt(4)
L_ad7:
  buffer_load_dwordx4 v3, s[32:35], s65 offen offset:1024 nt lds
  s_waitcnt vmcnt(6)
  s_cmp_ge_u32 s69, 2
  s_cbranch_scc1 L_ad8
  s_waitcnt vmcnt(5)
  s_cmp_ge_u32 s69, 1
  s_cbranch_scc1 L_ad8
  s_waitcnt vmcnt(4)
L_ad8:
  buffer_load_dwordx4 v4, s[32:35], s65 offen offset:2048 nt lds
  s_waitcnt vmcnt(6)
  s_cmp_ge_u32 s69, 2
  s_cbranch_scc1 L_ad9
  s_waitcnt vmcnt(5)
  s_cmp_ge_u32 s69, 1
  s_cbranch_scc1 L_ad9
  s_waitcnt vmcnt(4)
L_ad9:
  buffer_load_dwordx4 v5, s[32:35], s65 offen offset:3072 nt lds
  s_waitcnt vmcnt(6)
  s_cmp_ge_u32 s69, 2
  s_cbranch_scc1 L_ad10
  s_waitcnt vmcnt(5)
  s_cmp_ge_u32 s69, 1
  s_cbranch_scc1 L_ad10
  s_waitcnt vmcnt(4)
L_ad10:
  s_add_u32 m0, s64, 24576
  s_mov_b32 s65, 360448
  buffer_load_dwordx4 v2, s[32:35], s65 offen offset:0 nt lds
  ds_read_b128 v[160:163], v8 offset:12288
  ds_read_b128 v[164:167], v9 offset:12288
  ds_read_b128 v[168:171], v10 offset:12288
  ds_read_b128 v[172:175], v11 offset:12288
  s_waitcnt lgkmcnt(3)
  v_mfma_f32_16x16x32_bf16 v[116:119], v[160:163], v[48:51], v[116:119]
  s_waitcnt lgkmcnt(2)
  v_mfma_f32_16x16x32_bf16 v[116:119], v[164:167], v[52:55], v[116:119]
  s_waitcnt lgkmcnt(1)
  v_mfma_f32_16x16x32_bf16 v[116:119], v[168:171], v[56:59], v[116:119]
  s_waitcnt lgkmcnt(0)
  v_mfma_f32_16x16x32_bf16 v[116:119], v[172:175], v[60:63], v[116:119]
  s_waitcnt vmcnt(6)
  s_cmp_ge_u32 s69, 2
  s_cbranch_scc1 L_ad11
  s_waitcnt vmcnt(5)
  s_cmp_ge_u32 s69, 1
  s_cbranch_scc1 L_ad11
  s_waitcnt vmcnt(4)
L_ad11:
  buffer_load_dwordx4 v3, s[32:35], s65 offen offset:1024 nt lds
  s_waitcnt vmcnt(6)
  s_cmp_ge_u32 s69, 2
  s_cbranch_scc1 L_ad12
  s_waitcnt vmcnt(5)
  s_cmp_ge_u32 s69, 1
  s_cbranch_scc1 L_ad12
  s_waitcnt vmcnt(4)
L_ad12:
  buffer_load_dwordx4 v4, s[32:35], s65 offen offset:2048 nt lds
  s_waitcnt vmcnt(6)
  s_cmp_ge_u32 s69, 2
  s_cbranch_scc1 L_ad13
  s_waitcnt vmcnt(5)
  s_cmp_ge_u32 s69, 1
  s_cbranch_scc1 L_ad13
  s_waitcnt vmcnt(4)
L_ad13:
  buffer_load_dwordx4 v5, s[32:35], s65 offen offset:3072 nt lds
  v_readfirstlane_b32 s69, v253
  ds_read_b32 v253, v254
  s_waitcnt vmcnt(6)
  s_cmp_ge_u32 s69, 2
  s_cbranch_scc1 L_ad14
  s_waitcnt vmcnt(5)
  s_cmp_ge_u32 s69, 1
  s_cbranch_scc1 L_ad14
  s_waitcnt vmcnt(4)
L_ad14:
  s_add_u32 m0, s64, 28672
  s_mov_b32 s65, 376832
  buffer_load_dwordx4 v2, s[32:35], s65 offen offset:0 nt lds
  ds_read_b128 v[144:147], v8 offset:16384
  ds_read_b128 v[148:151], v9 offset:16384
  ds_read_b128 v[152:155], v10 offset:16384
  ds_read_b128 v[156:159], v11 offset:16384
  s_waitcnt lgkmcnt(3)
  v_mfma_f32_16x16x32_bf16 v[112:115], v[144:147], v[64:67], v[112:115]
  s_waitcnt lgkmcnt(2)
  v_mfma_f32_16x16x32_bf16 v[112:115], v[148:151], v[68:71], v[112:115]
  s_waitcnt lgkmcnt(1)
  v_mfma_f32_16x16x32_bf16 v[112:115], v[152:155], v[72:75], v[112:115]
  s_waitcnt lgkmcnt(0)
  v_mfma_f32_16x16x32_bf16 v[112:115], v[156:159], v[76:79], v[112:115]
  s_waitcnt vmcnt(6)
  s_cmp_ge_u32 s69, 2
  s_cbranch_scc1 L_ad15
  s_waitcnt vmcnt(5)
  s_cmp_ge_u32 s69, 1
  s_cbranch_scc1 L_ad15
  s_waitcnt vmcnt(4)
L_ad15:
  buffer_load_dwordx4 v3, s[32:35], s65 offen offset:1024 nt lds
  s_waitcnt vmcnt(6)
  s_cmp_ge_u32 s69, 2
  s_cbranch_scc1 L_ad16
  s_waitcnt vmcnt(5)
  s_cmp_ge_u32 s69, 1
  s_cbranch_scc1 L_ad16
  s_waitcnt vmcnt(4)
L_ad16:
  buffer_load_dwordx4 v4, s[32:35], s65 offen offset:2048 nt lds
  s_waitcnt vmcnt(6)
  s_cmp_ge_u32 s69, 2
  s_cbranch_scc1 L_ad17
  s_waitcnt vmcnt(5)
  s_cmp_ge_u32 s69, 1
  s_cbranch_scc1 L_ad17
  s_waitcnt vmcnt(4)
L_ad17:
  buffer_load_dwordx4 v5, s[32:35], s65 offen offset:3072 nt lds
  s_waitcnt vmcnt(6)
  s_cmp_ge_u32 s69, 2
  s_cbranch_scc1 L_ad18
  s_waitcnt vmcnt(5)
  s_cmp_ge_u32 s69, 1
  s_cbranch_scc1 L_ad18
  s_waitcnt vmcnt(4)
L_ad18:
  s_add_u32 m0, s64, 0
  s_mov_b32 s65, 393216
  buffer_load_dwordx4 v2, s[32:35], s65 offen offset:0 nt lds
  ds_read_b128 v[160:163], v8 offset:20480
  ds_read_b128 v[164:167], v9 offset:20480
  ds_read_b128 v[168:171], v10 offset:20480
  ds_read_b128 v[172:175], v11 offset:20480
  s_waitcnt lgkmcnt(3)
  v_mfma_f32_16x16x32_bf16 v[116:119], v[160:163], v[64:67], v[116:119]
  s_waitcnt lgkmcnt(2)
  v_mfma_f32_16x16x32_bf16 v[116:119], v[164:167], v[68:71], v[116:119]
  s_waitcnt lgkmcnt(1)
  v_mfma_f32_16x16x32_bf16 v[116:119], v[168:171], v[72:75], v[116:119]
  s_waitcnt lgkmcnt(0)
  v_mfma_f32_16x16x32_bf16 v[116:119], v[172:175], v[76:79], v[116:119]
  s_waitcnt vmcnt(6)
  s_cmp_ge_u32 s69, 2
  s_cbranch_scc1 L_ad19
  s_waitcnt vmcnt(5)
  s_cmp_ge_u32 s69, 1
  s_cbranch_scc1 L_ad19
  s_waitcnt vmcnt(4)
L_ad19:
  buffer_load_dwordx4 v3, s[32:35], s65 offen offset:1024 nt lds
  s_waitcnt vmcnt(6)
  s_cmp_ge_u32 s69, 2
  s_cbranch_scc1 L_ad20
  s_waitcnt vmcnt(5)
  s_cmp_ge_u32 s69, 1
  s_cbranch_scc1 L_ad20
  s_waitcnt vmcnt(4)
L_ad20:
  buffer_load_dwordx4 v4, s[32:35], s65 offen offset:2048 nt lds
  s_waitcnt vmcnt(6)
  s_cmp_ge_u32 s69, 2
  s_cbranch_scc1 L_ad21
  s_waitcnt vmcnt(5)
  s_cmp_ge_u32 s69, 1
  s_cbranch_scc1 L_ad21
  s_waitcnt vmcnt(4)
L_ad21:
  buffer_load_dwordx4 v5, s[32:35], s65 offen offset:3072 nt lds
  v_readfirstlane_b32 s69, v253
  ds_read_b32 v253, v254
  s_cmp_lg_u32 s3, 0
  s_cbranch_scc1 L_ck22
  s_memrealtime s[84:85]
  s_waitcnt lgkmcnt(0)
  v_mov_b32 v26, 2
  v_mov_b32 v27, s84
  s_mov_b64 exec, 1
  ds_write_b64 v255, v[26:27]
  s_mov_b64 exec, -1
L_ck22:
  s_waitcnt vmcnt(6)
  s_cmp_ge_u32 s69, 2
  s_cbranch_scc1 L_ad23
  s_waitcnt vmcnt(5)
  s_cmp_ge_u32 s69, 1
  s_cbranch_scc1 L_ad23
  s_waitcnt vmcnt(4)
L_ad23:
  s_add_u32 m0, s64, 4096
  s_mov_b32 s65, 409600
  buffer_load_dwordx4 v2, s[32:35], s65 offen offset:0 nt lds
  ds_read_b128 v[144:147], v8 offset:24576
  ds_read_b128 v[148:151], v9 offset:24576
  ds_read_b128 v[152:155], v10 offset:24576
  ds_read_b128 v[156:159], v11 offset:24576
  s_waitcnt lgkmcnt(3)
  v_mfma_f32_16x16x32_bf16 v[112:115], v[144:147], v[80:83], v[112:115]
  s_waitcnt lgkmcnt(2)
  v_mfma_f32_16x16x32_bf16 v[112:115], v[148:151], v[84:87], v[112:115]
  s_waitcnt lgkmcnt(1)
  v_mfma_f32_16x16x32_bf16 v[112:115], v[152:155], v[88:91], v[112:115]
  s_waitcnt lgkmcnt(0)
  v_mfma_f32_16x16x32_bf16 v[112:115], v[156:159], v[92:95], v[112:115]
  s_waitcnt vmcnt(6)
  s_cmp_ge_u32 s69, 2
  s_cbranch_scc1 L_ad24
  s_waitcnt vmcnt(5)
  s_cmp_ge_u32 s69, 1
  s_cbranch_scc1 L_ad24
  s_waitcnt vmcnt(4)
L_ad24:
  buffer_load_dwordx4 v3, s[32:35], s65 offen offset:1024 nt lds
  s_waitcnt vmcnt(6)
  s_cmp_ge_u32 s69, 2
  s_cbranch_scc1 L_ad25
  s_waitcnt vmcnt(5)
  s_cmp_ge_u32 s69, 1
  s_cbranch_scc1 L_ad25
  s_waitcnt vmcnt(4)
L_ad25:
  buffer_load_dwordx4 v4, s[32:35], s65 offen offset:2048 nt lds
  s_waitcnt vmcnt(6)
  s_cmp_ge_u32 s69, 2
  s_cbranch_scc1 L_ad26
  s_waitcnt vmcnt(5)
  s_cmp_ge_u32 s69, 1
  s_cbranch_scc1 L_ad26
  s_waitcnt vmcnt(4)
L_ad26:
  buffer_load_dwordx4 v5, s[32:35], s65 offen offset:3072 nt lds
  s_waitcnt vmcnt(6)
  s_cmp_ge_u32 s69, 2
  s_cbranch_scc1 L_ad27
  s_waitcnt vmcnt(5)
  s_cmp_ge_u32 s69, 1
  s_cbranch_scc1 L_ad27
  s_waitcnt vmcnt(4)
L_ad27:
  s_add_u32 m0, s64, 8192
  s_mov_b32 s65, 425984
  buffer_load_dwordx4 v2, s[32:35], s65 offen offset:0 nt lds
  ds_read_b128 v[160:163], v8 offset:28672
  ds_read_b128 v[164:167], v9 offset:28672
  ds_read_b128 v[168:171], v10 offset:28672
  ds_read_b128 v[172:175], v11 offset:28672
  s_waitcnt lgkmcnt(3)
  v_mfma_f32_16x16x32_bf16 v[116:119], v[160:163], v[80:83], v[116:119]
  s_waitcnt lgkmcnt(2)
  v_mfma_f32_16x16x32_bf16 v[116:119], v[164:167], v[84:87], v[116:119]
  s_waitcnt lgkmcnt(1)
  v_mfma_f32_16x16x32_bf16 v[116:119], v[168:171], v[88:91], v[116:119]
  s_waitcnt lgkmcnt(0)
  v_mfma_f32_16x16x32_bf16 v[116:119], v[172:175], v[92:95], v[116:119]
  s_waitcnt vmcnt(6)
  s_cmp_ge_u32 s69, 2
  s_cbranch_scc1 L_ad28
  s_waitcnt vmcnt(5)
  s_cmp_ge_u32 s69, 1
  s_cbranch_scc1 L_ad28
  s_waitcnt vmcnt(4)
L_ad28:
  buffer_load_dwordx4 v3, s[32:35], s65 offen offset:1024 nt lds
  s_waitcnt vmcnt(6)
  s_cmp_ge_u32 s69, 2
  s_cbranch_scc1 L_ad29
  s_waitcnt vmcnt(5)
  s_cmp_ge_u32 s69, 1
  s_cbranch_scc1 L_ad29
  s_waitcnt vmcnt(4)
L_ad29:
  buffer_load_dwordx4 v4, s[32:35], s65 offen offset:2048 nt lds
  s_waitcnt vmcnt(6)
  s_cmp_ge_u32 s69, 2
  s_cbranch_scc1 L_ad30
  s_waitcnt vmcnt(5)
  s_cmp_ge_u32 s69, 1
  s_cbranch_scc1 L_ad30
  s_waitcnt vmcnt(4)
L_ad30:
  buffer_load_dwordx4 v5, s[32:35], s65 offen offset:3072 nt lds
  v_readfirstlane_b32 s69, v253
  ds_read_b32 v253, v254
  s_waitcnt vmcnt(6)
  s_cmp_ge_u32 s69, 2
  s_cbranch_scc1 L_ad31
  s_waitcnt vmcnt(5)
  s_cmp_ge_u32 s69, 1
  s_cbranch_scc1 L_ad31
  s_waitcnt vmcnt(4)
L_ad31:
  s_add_u32 m0, s64, 12288
  s_mov_b32 s65, 442368
  buffer_load_dwordx4 v2, s[32:35], s65 offen offset:0 nt lds
  ds_read_b128 v[144:147], v8 offset:0
  ds_read_b128 v[148:151], v9 offset:0
  ds_read_b128 v[152:155], v10 offset:0
  ds_read_b128 v[156:159], v11 offset:0
  s_waitcnt lgkmcnt(3)
  v_mfma_f32_16x16x32_bf16 v[120:123], v[144:147], v[32:35], 0
  s_waitcnt lgkmcnt(2)
  v_mfma_f32_16x16x32_bf16 v[120:123], v[148:151], v[36:39], v[120:123]
  s_waitcnt lgkmcnt(1)
  v_mfma_f32_16x16x32_bf16 v[120:123], v[152:155], v[40:43], v[120:123]
  s_waitcnt lgkmcnt(0)
  v_mfma_f32_16x16x32_bf16 v[120:123], v[156:159], v[44:47], v[120:123]
  s_waitcnt vmcnt(6)
  s_cmp_ge_u32 s69, 2
  s_cbranch_scc1 L_ad32
  s_waitcnt vmcnt(5)
  s_cmp_ge_u32 s69, 1
  s_cbranch_scc1 L_ad32
  s_waitcnt vmcnt(4)
L_ad32:
  buffer_load_dwordx4 v3, s[32:35], s65 offen offset:1024 nt lds
  s_waitcnt vmcnt(6)
  s_cmp_ge_u32 s69, 2
  s_cbranch_scc1 L_ad33
  s_waitcnt vmcnt(5)
  s_cmp_ge_u32 s69, 1
  s_cbranch_scc1 L_ad33
  s_waitcnt vmcnt(4)
L_ad33:
  buffer_load_dwordx4 v4, s[32:35], s65 offen offset:2048 nt lds
  s_waitcnt vmcnt(6)
  s_cmp_ge_u32 s69, 2
  s_cbranch_scc1 L_ad34
  s_waitcnt vmcnt(5)
  s_cmp_ge_u32 s69, 1
  s_cbranch_scc1 L_ad34
  s_waitcnt vmcnt(4)
L_ad34:
  buffer_load_dwordx4 v5, s[32:35], s65 offen offset:3072 nt lds
  s_waitcnt vmcnt(6)
  s_cmp_ge_u32 s69, 2
  s_cbranch_scc1 L_ad35
  s_waitcnt vmcnt(5)
  s_cmp_ge_u32 s69, 1
  s_cbranch_scc1 L_ad35
  s_waitcnt vmcnt(4)
L_ad35:
  s_add_u32 m0, s64, 16384
  s_mov_b32 s65, 458752
  buffer_load_dwordx4 v2, s[32:35], s65 offen offset:0 nt lds
  ds_read_b128 v[160:163], v8 offset:4096
  ds_read_b128 v[164:167], v9 offset:4096
  ds_read_b128 v[168:171], v10 offset:4096
  ds_read_b128 v[172:175], v11 offset:4096
  s_waitcnt lgkmcnt(3)
  v_mfma_f32_16x16x32_bf16 v[124:127], v[160:163], v[32:35], 0
  s_waitcnt lgkmcnt(2)
  v_mfma_f32_16x16x32_bf16 v[124:127], v[164:167], v[36:39], v[124:127]
  s_waitcnt lgkmcnt(1)
  v_mfma_f32_16x16x32_bf16 v[124:127], v[168:171], v[40:43], v[124:127]
  s_waitcnt lgkmcnt(0)
  v_mfma_f32_16x16x32_bf16 v[124:127], v[172:175], v[44:47], v[124:127]
  s_waitcnt vmcnt(6)
  s_cmp_ge_u32 s69, 2
  s_cbranch_scc1 L_ad36
  s_waitcnt vmcnt(5)
  s_cmp_ge_u32 s69, 1
  s_cbranch_scc1 L_ad36
  s_waitcnt vmcnt(4)
L_ad36:
  buffer_load_dwordx4 v3, s[32:35], s65 offen offset:1024 nt lds
  s_waitcnt vmcnt(6)
  s_cmp_ge_u32 s69, 2
  s_cbranch_scc1 L_ad37
  s_waitcnt vmcnt(5)
  s_cmp_ge_u32 s69, 1
  s_cbranch_scc1 L_ad37
  s_waitcnt vmcnt(4)
L_ad37:
  buffer_load_dwordx4 v4, s[32:35], s65 offen offset:2048 nt lds
  s_waitcnt vmcnt(6)
  s_cmp_ge_u32 s69, 2
  s_cbranch_scc1 L_ad38
  s_waitcnt vmcnt(5)
  s_cmp_ge_u32 s69, 1
  s_cbranch_scc1 L_ad38
  s_waitcnt vmcnt(4)
L_ad38:
  buffer_load_dwordx4 v5, s[32:35], s65 offen offset:3072 nt lds
  v_readfirstlane_b32 s69, v253
  ds_read_b32 v253, v254
  s_waitcnt vmcnt(6)
  s_cmp_ge_u32 s69, 2
  s_cbranch_scc1 L_ad39
  s_waitcnt vmcnt(5)
  s_cmp_ge_u32 s69, 1
  s_cbranch_scc1 L_ad39
  s_waitcnt vmcnt(4)
L_ad39:
  s_add_u32 m0, s64, 20480
  s_mov_b32 s65, 475136
  buffer_load_dwordx4 v2, s[32:35], s65 offen offset:0 nt lds
  ds_read_b128 v[144:147], v8 offset:8192
  ds_read_b128 v[148:151], v9 offset:8192
  ds_read_b128 v[152:155], v10 offset:8192
  ds_read_b128 v[156:159], v11 offset:8192
  s_waitcnt lgkmcnt(3)
  v_mfma_f32_16x16x32_bf16 v[120:123], v[144:147], v[48:51], v[120:123]
  s_waitcnt lgkmcnt(2)
  v_mfma_f32_16x16x32_bf16 v[120:123], v[148:151], v[52:55], v[120:123]
  s_waitcnt lgkmcnt(1)
  v_mfma_f32_16x16x32_bf16 v[120:123], v[152:155], v[56:59], v[120:123]
  s_waitcnt lgkmcnt(0)
  v_mfma_f32_16x16x32_bf16 v[120:123], v[156:159], v[60:63], v[120:123]
  s_waitcnt vmcnt(6)
  s_cmp_ge_u32 s69, 2
  s_cbranch_scc1 L_ad40
  s_waitcnt vmcnt(5)
  s_cmp_ge_u32 s69, 1
  s_cbranch_scc1 L_ad40
  s_waitcnt vmcnt(4)
L_ad40:
  buffer_load_dwordx4 v3, s[32:35], s65 offen offset:1024 nt lds
  s_waitcnt vmcnt(6)
  s_cmp_ge_u32 s69, 2
  s_cbranch_scc1 L_ad41
  s_waitcnt vmcnt(5)
  s_cmp_ge_u32 s69, 1
  s_cbranch_scc1 L_ad41
  s_waitcnt vmcnt(4)
L_ad41:
  buffer_load_dwordx4 v4, s[32:35], s65 offen offset:2048 nt lds
  s_waitcnt vmcnt(6)
  s_cmp_ge_u32 s69, 2
  s_cbranch_scc1 L_ad42
  s_waitcnt vmcnt(5)
  s_cmp_ge_u32 s69, 1
  s_cbranch_scc1 L_ad42
  s_waitcnt vmcnt(4)
L_ad42:
  buffer_load_dwordx4 v5, s[32:35], s65 offen offset:3072 nt lds
  s_waitcnt vmcnt(6)
  s_cmp_ge_u32 s69, 2
  s_cbranch_scc1 L_ad43
  s_waitcnt vmcnt(5)
  s_cmp_ge_u32 s69, 1
  s_cbranch_scc1 L_ad43
  s_waitcnt vmcnt(4)
L_ad43:
  s_add_u32 m0, s64, 24576
  s_mov_b32 s65, 491520
  buffer_load_dwordx4 v2, s[32:35], s65 offen offset:0 nt lds
  ds_read_b128 v[160:163], v8 offset:12288
  ds_read_b128 v[164:167], v9 offset:12288
  ds_read_b128 v[168:171], v10 offset:12288
  ds_read_b128 v[172:175], v11 offset:12288
  s_waitcnt lgkmcnt(3)
  v_mfma_f32_16x16x32_bf16 v[124:127], v[160:163], v[48:51], v[124:127]
  s_waitcnt lgkmcnt(2)
  v_mfma_f32_16x16x32_bf16 v[124:127], v[164:167], v[52:55], v[124:127]
  s_waitcnt lgkmcnt(1)
  v_mfma_f32_16x16x32_bf16 v[124:127], v[168:171], v[56:59], v[124:127]
  s_waitcnt lgkmcnt(0)
  v_mfma_f32_16x16x32_bf16 v[124:127], v[172:175], v[60:63], v[124:127]
  s_waitcnt vmcnt(6)
  s_cmp_ge_u32 s69, 2
  s_cbranch_scc1 L_ad44
  s_waitcnt vmcnt(5)
  s_cmp_ge_u32 s69, 1
  s_cbranch_scc1 L_ad44
  s_waitcnt vmcnt(4)
L_ad44:
  buffer_load_dwordx4 v3, s[32:35], s65 offen offset:1024 nt lds
  s_waitcnt vmcnt(6)
  s_cmp_ge_u32 s69, 2
  s_cbranch_scc1 L_ad45
  s_waitcnt vmcnt(5)
  s_cmp_ge_u32 s69, 1
  s_cbranch_scc1 L_ad45
  s_waitcnt vmcnt(4)
L_ad45:
  buffer_load_dwordx4 v4, s[32:35], s65 offen offset:2048 nt lds
  s_waitcnt vmcnt(6)
  s_cmp_ge_u32 s69, 2
  s_cbranch_scc1 L_ad46
  s_waitcnt vmcnt(5)
  s_cmp_ge_u32 s69, 1
  s_cbranch_scc1 L_ad46
  s_waitcnt vmcnt(4)
L_ad46:
  buffer_load_dwordx4 v5, s[32:35], s65 offen offset:3072 nt lds
  v_readfirstlane_b32 s69, v253
  ds_read_b32 v253, v254
  s_cmp_lg_u32 s3, 0
  s_cbranch_scc1 L_ck47
  s_memrealtime s[84:85]
  s_waitcnt lgkmcnt(0)
  v_mov_b32 v26, 3
  v_mov_b32 v27, s84
  s_mov_b64 exec, 1
  ds_write_b64 v255, v[26:27]
  s_mov_b64 exec, -1
L_ck47:
  s_waitcnt vmcnt(6)
  s_cmp_ge_u32 s69, 2
  s_cbranch_scc1 L_ad48
  s_waitcnt vmcnt(5)
  s_cmp_ge_u32 s69, 1
  s_cbranch_scc1 L_ad48
  s_waitcnt vmcnt(4)
L_ad48:
  s_add_u32 m0, s64, 28672
  s_mov_b32 s65, 507904
  buffer_load_dwordx4 v2, s[32:35], s65 offen offset:0 nt lds
  ds_read_b128 v[144:147], v8 offset:16384
  ds_read_b128 v[148:151], v9 offset:16384
  ds_read_b128 v[152:155], v10 offset:16384
  ds_read_b128 v[156:159], v11 offset:16384
  s_waitcnt lgkmcnt(3)
  v_mfma_f32_16x16x32_bf16 v[120:123], v[144:147], v[64:67], v[120:123]
  s_waitcnt lgkmcnt(2)
  v_mfma_f32_16x16x32_bf16 v[120:123], v[148:151], v[68:71], v[120:123]
  s_waitcnt lgkmcnt(1)
  v_mfma_f32_16x16x32_bf16 v[120:123], v[152:155], v[72:75], v[120:123]
  s_waitcnt lgkmcnt(0)
  v_mfma_f32_16x16x32_bf16 v[120:123], v[156:159], v[76:79], v[120:123]
  s_waitcnt vmcnt(6)
  s_cmp_ge_u32 s69, 2
  s_cbranch_scc1 L_ad49
  s_waitcnt vmcnt(5)
  s_cmp_ge_u32 s69, 1
  s_cbranch_scc1 L_ad49
  s_waitcnt vmcnt(4)
L_ad49:
  buffer_load_dwordx4 v3, s[32:35], s65 offen offset:1024 nt lds
  s_waitcnt vmcnt(6)
  s_cmp_ge_u32 s69, 2
  s_cbranch_scc1 L_ad50
  s_waitcnt vmcnt(5)
  s_cmp_ge_u32 s69, 1
  s_cbranch_scc1 L_ad50
  s_waitcnt vmcnt(4)
L_ad50:
  buffer_load_dwordx4 v4, s[32:35], s65 offen offset:2048 nt lds
  s_waitcnt vmcnt(6)
  s_cmp_ge_u32 s69, 2
  s_cbranch_scc1 L_ad51
  s_waitcnt vmcnt(5)
  s_cmp_ge_u32 s69, 1
  s_cbranch_scc1 L_ad51
  s_waitcnt vmcnt(4)
L_ad51:
  buffer_load_dwordx4 v5, s[32:35], s65 offen offset:3072 nt lds
  s_waitcnt vmcnt(6)
  s_cmp_ge_u32 s69, 2
  s_cbranch_scc1 L_ad52
  s_waitcnt vmcnt(5)
  s_cmp_ge_u32 s69, 1
  s_cbranch_scc1 L_ad52
  s_waitcnt vmcnt(4)
L_ad52:
  s_add_u32 m0, s64, 0
  s_mov_b32 s65, 0
  buffer_load_dwordx4 v6, s[36:39], s65 offen offset:0 nt lds
  ds_read_b128 v[160:163], v8 offset:20480
  ds_read_b128 v[164:167], v9 offset:20480
  ds_read_b128 v[168:171], v10 offset:20480
  ds_read_b128 v[172:175], v11 offset:20480
  s_waitcnt lgkmcnt(3)
  v_mfma_f32_16x16x32_bf16 v[124:127], v[160:163], v[64:67], v[124:127]
  s_waitcnt lgkmcnt(2)
  v_mfma_f32_16x16x32_bf16 v[124:127], v[164:167], v[68:71], v[124:127]
  s_waitcnt lgkmcnt(1)
  v_mfma_f32_16x16x32_bf16 v[124:127], v[168:171], v[72:75], v[124:127]
  s_waitcnt lgkmcnt(0)
  v_mfma_f32_16x16x32_bf16 v[124:127], v[172:175], v[76:79], v[124:127]
  s_waitcnt vmcnt(6)
  s_cmp_ge_u32 s69, 2
  s_cbranch_scc1 L_ad53
  s_waitcnt vmcnt(5)
  s_cmp_ge_u32 s69, 1
  s_cbranch_scc1 L_ad53
  s_waitcnt vmcnt(4)
L_ad53:
  buffer_load_dwordx4 v7, s[36:39], s65 offen offset:1024 nt lds
  s_waitcnt vmcnt(6)
  s_cmp_ge_u32 s69, 2
  s_cbranch_scc1 L_ad54
  s_waitcnt vmcnt(5)
  s_cmp_ge_u32 s69, 1
  s_cbranch_scc1 L_ad54
  s_waitcnt vmcnt(4)
L_ad54:
  buffer_load_dwordx4 v6, s[36:39], s65 offen offset:2048 nt lds
  s_waitcnt vmcnt(6)
  s_cmp_ge_u32 s69, 2
  s_cbranch_scc1 L_ad55
  s_waitcnt vmcnt(5)
  s_cmp_ge_u32 s69, 1
  s_cbranch_scc1 L_ad55
  s_waitcnt vmcnt(4)
L_ad55:
  buffer_load_dwordx4 v7, s[36:39], s65 offen offset:3072 nt lds
  v_readfirstlane_b32 s69, v253
  ds_read_b32 v253, v254
  s_waitcnt vmcnt(6)
  s_cmp_ge_u32 s69, 2
  s_cbranch_scc1 L_ad56
  s_waitcnt vmcnt(5)
  s_cmp_ge_u32 s69, 1
  s_cbranch_scc1 L_ad56
  s_waitcnt vmcnt(4)
L_ad56:
  s_add_u32 m0, s64, 4096
  s_mov_b32 s65, 16384
  buffer_load_dwordx4 v6, s[36:39], s65 offen offset:0 nt lds
  ds_read_b128 v[144:147], v8 offset:24576
  ds_read_b128 v[148:151], v9 offset:24576
  ds_read_b128 v[152:155], v10 offset:24576
  ds_read_b128 v[156:159], v11 offset:24576
  s_waitcnt lgkmcnt(3)
  v_mfma_f32_16x16x32_bf16 v[120:123], v[144:147], v[80:83], v[120:123]
  s_waitcnt lgkmcnt(2)
  v_mfma_f32_16x16x32_bf16 v[120:123], v[148:151], v[84:87], v[120:123]
  s_waitcnt lgkmcnt(1)
  v_mfma_f32_16x16x32_bf16 v[120:123], v[152:155], v[88:91], v[120:123]
  s_waitcnt lgkmcnt(0)
  v_mfma_f32_16x16x32_bf16 v[120:123], v[156:159], v[92:95], v[120:123]
  s_waitcnt vmcnt(6)
  s_cmp_ge_u32 s69, 2
  s_cbranch_scc1 L_ad57
  s_waitcnt vmcnt(5)
  s_cmp_ge_u32 s69, 1
  s_cbranch_scc1 L_ad57
  s_waitcnt vmcnt(4)
L_ad57:
  buffer_load_dwordx4 v7, s[36:39], s65 offen offset:1024 nt lds
  s_waitcnt vmcnt(6)
  s_cmp_ge_u32 s69, 2
  s_cbranch_scc1 L_ad58
  s_waitcnt vmcnt(5)
  s_cmp_ge_u32 s69, 1
  s_cbranch_scc1 L_ad58
  s_waitcnt vmcnt(4)
L_ad58:
  buffer_load_dwordx4 v6, s[36:39], s65 offen offset:2048 nt lds
  s_waitcnt vmcnt(6)
  s_cmp_ge_u32 s69, 2
  s_cbranch_scc1 L_ad59
  s_waitcnt vmcnt(5)
  s_cmp_ge_u32 s69, 1
  s_cbranch_scc1 L_ad59
  s_waitcnt vmcnt(4)
L_ad59:
  buffer_load_dwordx4 v7, s[36:39], s65 offen offset:3072 nt lds
  s_waitcnt vmcnt(6)
  s_cmp_ge_u32 s69, 2
  s_cbranch_scc1 L_ad60
  s_waitcnt vmcnt(5)
  s_cmp_ge_u32 s69, 1
  s_cbranch_scc1 L_ad60
  s_waitcnt vmcnt(4)
L_ad60:
  s_add_u32 m0, s64, 8192
  s_mov_b32 s65, 32768
  buffer_load_dwordx4 v6, s[36:39], s65 offen offset:0 nt lds
  ds_read_b128 v[160:163], v8 offset:28672
  ds_read_b128 v[164:167], v9 offset:28672
  ds_read_b128 v[168:171], v10 offset:28672
  ds_read_b128 v[172:175], v11 offset:28672
  s_waitcnt lgkmcnt(3)
  v_mfma_f32_16x16x32_bf16 v[124:127], v[160:163], v[80:83], v[124:127]
  s_waitcnt lgkmcnt(2)
  v_mfma_f32_16x16x32_bf16 v[124:127], v[164:167], v[84:87], v[124:127]
  s_waitcnt lgkmcnt(1)
  v_mfma_f32_16x16x32_bf16 v[124:127], v[168:171], v[88:91], v[124:127]
  s_waitcnt lgkmcnt(0)
  v_mfma_f32_16x16x32_bf16 v[124:127], v[172:175], v[92:95], v[124:127]
  s_waitcnt vmcnt(6)
  s_cmp_ge_u32 s69, 2
  s_cbranch_scc1 L_ad61
  s_waitcnt vmcnt(5)
  s_cmp_ge_u32 s69, 1
  s_cbranch_scc1 L_ad61
  s_waitcnt vmcnt(4)
L_ad61:
  buffer_load_dwordx4 v7, s[36:39], s65 offen offset:1024 nt lds
  s_waitcnt vmcnt(6)
  s_cmp_ge_u32 s69, 2
  s_cbranch_scc1 L_ad62
  s_waitcnt vmcnt(5)
  s_cmp_ge_u32 s69, 1
  s_cbranch_scc1 L_ad62
  s_waitcnt vmcnt(4)
L_ad62:
  buffer_load_dwordx4 v6, s[36:39], s65 offen offset:2048 nt lds
  s_waitcnt vmcnt(6)
  s_cmp_ge_u32 s69, 2
  s_cbranch_scc1 L_ad63
  s_waitcnt vmcnt(5)
  s_cmp_ge_u32 s69, 1
  s_cbranch_scc1 L_ad63
  s_waitcnt vmcnt(4)
L_ad63:
  buffer_load_dwordx4 v7, s[36:39], s65 offen offset:3072 nt lds
  s_add_u32 m0, s64, 12288
  s_mov_b32 s65, 49152
  buffer_load_dwordx4 v6, s[36:39], s65 offen offset:0 nt lds
  buffer_load_dwordx4 v7, s[36:39], s65 offen offset:1024 nt lds
  buffer_load_dwordx4 v6, s[36:39], s65 offen offset:2048 nt lds
  s_nop 7
  s_mov_b32 s78, 0x3e0293ee
  v_max3_f32 v25, v96, v97, v98
  v_max3_f32 v25, v25, v99, v100
  v_max3_f32 v25, v25, v101, v102
  v_max3_f32 v25, v25, v103, v104
  v_max3_f32 v25, v25, v105, v106
  v_max3_f32 v25, v25, v107, v108
  v_max3_f32 v25, v25, v109, v110
  v_max3_f32 v25, v25, v111, v112
  v_max3_f32 v25, v25, v113, v114
  v_max3_f32 v25, v25, v115, v116
  v_max3_f32 v25, v25, v117, v118
  v_max3_f32 v25, v25, v119, v120
  v_max3_f32 v25, v25, v121, v122
  v_max3_f32 v25, v25, v123, v124
  v_max3_f32 v25, v25, v125, v126
  v_max_f32 v25, v25, v127
  s_nop 1
  v_max_f32_dpp v25, v25, v25 row_ror:4 row_mask:0xf bank_mask:0xf
  s_nop 1
  v_max_f32_dpp v25, v25, v25 row_ror:8 row_mask:0xf bank_mask:0xf
  v_mov_b32 v26, v25
  s_nop 1
  v_permlane16_swap_b32 v25, v26
  v_max_f32 v25, v25, v26
  v_mov_b32 v26, v25
  s_nop 1
  v_permlane32_swap_b32 v25, v26
  v_max_f32 v25, v25, v26
  v_mul_f32 v25, s78, v25
  v_fma_f32 v96, v96, s78, -v25
  v_fma_f32 v97, v97, s78, -v25
  v_fma_f32 v98, v98, s78, -v25
  v_fma_f32 v99, v99, s78, -v25
  v_fma_f32 v100, v100, s78, -v25
  v_fma_f32 v101, v101, s78, -v25
  v_fma_f32 v102, v102, s78, -v25
  v_fma_f32 v103, v103, s78, -v25
  v_fma_f32 v104, v104, s78, -v25
  v_fma_f32 v105, v105, s78, -v25
  v_fma_f32 v106, v106, s78, -v25
  v_fma_f32 v107, v107, s78, -v25
  v_fma_f32 v108, v108, s78, -v25
  v_fma_f32 v109, v109, s78, -v25
  v_fma_f32 v110, v110, s78, -v25
  v_fma_f32 v111, v111, s78, -v25
  v_fma_f32 v112, v112, s78, -v25
  v_fma_f32 v113, v113, s78, -v25
  v_fma_f32 v114, v114, s78, -v25
  v_fma_f32 v115, v115, s78, -v25
  v_fma_f32 v116, v116, s78, -v25
  v_fma_f32 v117, v117, s78, -v25
  v_fma_f32 v118, v118, s78, -v25
  v_fma_f32 v119, v119, s78, -v25
  v_fma_f32 v120, v120, s78, -v25
  v_fma_f32 v121, v121, s78, -v25
  v_fma_f32 v122, v122, s78, -v25
  v_fma_f32 v123, v123, s78, -v25
  v_fma_f32 v124, v124, s78, -v25
  v_fma_f32 v125, v125, s78, -v25
  v_fma_f32 v126, v126, s78, -v25
  v_fma_f32 v127, v127, s78, -v25
  v_exp_f32 v96, v96
  v_exp_f32 v97, v97
  v_exp_f32 v98, v98
  v_exp_f32 v99, v99
  v_exp_f32 v100, v100
  v_exp_f32 v101, v101
  v_exp_f32 v102, v102
  v_exp_f32 v103, v103
  v_exp_f32 v104, v104
  v_exp_f32 v105, v105
  v_exp_f32 v106, v106
  v_exp_f32 v107, v107
  v_exp_f32 v108, v108
  v_exp_f32 v109, v109
  v_exp_f32 v110, v110
  v_exp_f32 v111, v111
  v_exp_f32 v112, v112
  v_exp_f32 v113, v113
  v_exp_f32 v114, v114
  v_exp_f32 v115, v115
  v_exp_f32 v116, v116
  v_exp_f32 v117, v117
  v_exp_f32 v118, v118
  v_exp_f32 v119, v119
  v_exp_f32 v120, v120
  v_exp_f32 v121, v121
  v_exp_f32 v122, v122
  v_exp_f32 v123, v123
  v_exp_f32 v124, v124
  v_exp_f32 v125, v125
  v_exp_f32 v126, v126
  v_exp_f32 v127, v127
  v_add_f32 v27, v96, v100
  v_add_f32 v28, v97, v101
  v_add_f32 v29, v98, v102
  v_add_f32 v30, v99, v103
  v_add_f32 v27, v27, v104
  v_add_f32 v28, v28, v105
  v_add_f32 v29, v29, v106
  v_add_f32 v30, v30, v107
  v_add_f32 v27, v27, v108
  v_add_f32 v28, v28, v109
  v_add_f32 v29, v29, v110
  v_add_f32 v30, v30, v111
  v_add_f32 v27, v27, v112
  v_add_f32 v28, v28, v113
  v_add_f32 v29, v29, v114
  v_add_f32 v30, v30, v115
  v_add_f32 v27, v27, v116
  v_add_f32 v28, v28, v117
  v_add_f32 v29, v29, v118
  v_add_f32 v30, v30, v119
  v_add_f32 v27, v27, v120
  v_add_f32 v28, v28, v121
  v_add_f32 v29, v29, v122
  v_add_f32 v30, v30, v123
  v_add_f32 v27, v27, v124
  v_add_f32 v28, v28, v125
  v_add_f32 v29, v29, v126
  v_add_f32 v30, v30, v127
  v_cvt_pk_bf16_f32 v128, v96, v97
  v_cvt_pk_bf16_f32 v129, v98, v99
  v_cvt_pk_bf16_f32 v130, v100, v101
  v_cvt_pk_bf16_f32 v131, v102, v103
  v_cvt_pk_bf16_f32 v132, v104, v105
  v_cvt_pk_bf16_f32 v133, v106, v107
  v_cvt_pk_bf16_f32 v134, v108, v109
  v_cvt_pk_bf16_f32 v135, v110, v111
  v_cvt_pk_bf16_f32 v136, v112, v113
  v_cvt_pk_bf16_f32 v137, v114, v115
  v_cvt_pk_bf16_f32 v138, v116, v117
  v_cvt_pk_bf16_f32 v139, v118, v119
  v_cvt_pk_bf16_f32 v140, v120, v121
  v_cvt_pk_bf16_f32 v141, v122, v123
  v_cvt_pk_bf16_f32 v142, v124, v125
  v_cvt_pk_bf16_f32 v143, v126, v127
  v_add_f32 v27, v27, v28
  v_add_f32 v29, v29, v30
  v_add_f32 v27, v27, v29
  s_nop 1
  v_add_f32_dpp v27, v27, v27 row_ror:4 row_mask:0xf bank_mask:0xf
  s_nop 1
  v_add_f32_dpp v27, v27, v27 row_ror:8 row_mask:0xf bank_mask:0xf
  v_mov_b32 v26, v27
  s_nop 1
  v_permlane16_swap_b32 v27, v26
  v_add_f32 v27, v27, v26
  v_mov_b32 v26, v27
  s_nop 1
  v_permlane32_swap_b32 v27, v26
  v_add_f32 v27, v27, v26
  v_mov_b32 v30, v25
  v_mov_b32 v31, v27
  s_lshl_b32 s79, s3, 5
  s_add_u32 s79, s79, 150656
  v_lshlrev_b32 v21, 3, v1
  v_add_u32 v21, s79, v21
  s_mov_b64 exec, 15
  ds_write_b64 v21, v[30:31]
  v_mov_b32 v27, 151040
  v_mov_b32 v28, 1
  s_mov_b64 exec, 1
  ds_add_u32 v27, v28
  s_mov_b64 exec, -1
  ds_read_b64_tr_b16 v[144:145], v12 offset:0
  ds_read_b64_tr_b16 v[148:149], v13 offset:0
  ds_read_b64_tr_b16 v[152:153], v14 offset:0
  ds_read_b64_tr_b16 v[156:157], v15 offset:0
  ds_read_b64_tr_b16 v[160:161], v16 offset:0
  ds_read_b64_tr_b16 v[164:165], v17 offset:0
  ds_read_b64_tr_b16 v[168:169], v18 offset:0
  ds_read_b64_tr_b16 v[172:173], v19 offset:0
  s_waitcnt vmcnt(6)
  s_cmp_ge_u32 s69, 2
  s_cbranch_scc1 L_ad64
  s_waitcnt vmcnt(5)
  s_cmp_ge_u32 s69, 1
  s_cbranch_scc1 L_ad64
  s_waitcnt vmcnt(4)
L_ad64:
  buffer_load_dwordx4 v7, s[36:39], s65 offen offset:3072 nt lds
  s_waitcnt vmcnt(6)
  s_cmp_ge_u32 s69, 2
  s_cbranch_scc1 L_ad65
  s_waitcnt vmcnt(5)
  s_cmp_ge_u32 s69, 1
  s_cbranch_scc1 L_ad65
  s_waitcnt vmcnt(4)
L_ad65:
  s_add_u32 m0, s64, 16384
  s_mov_b32 s65, 65536
  buffer_load_dwordx4 v6, s[36:39], s65 offen offset:0 nt lds
  ds_read_b64_tr_b16 v[146:147], v12 offset:4096
  ds_read_b64_tr_b16 v[150:151], v13 offset:4096
  ds_read_b64_tr_b16 v[154:155], v14 offset:4096
  ds_read_b64_tr_b16 v[158:159], v15 offset:4096
  ds_read_b64_tr_b16 v[162:163], v16 offset:4096
  ds_read_b64_tr_b16 v[166:167], v17 offset:4096
  ds_read_b64_tr_b16 v[170:171], v18 offset:4096
  ds_read_b64_tr_b16 v[174:175], v19 offset:4096
  s_waitcnt lgkmcnt(7)
  v_mfma_f32_16x16x32_bf16 v[208:211], v[128:131], v[144:147], 0
  s_waitcnt lgkmcnt(6)
  v_mfma_f32_16x16x32_bf16 v[212:215], v[128:131], v[148:151], 0
  s_waitcnt lgkmcnt(5)
  v_mfma_f32_16x16x32_bf16 v[216:219], v[128:131], v[152:155], 0
  s_waitcnt lgkmcnt(4)
  v_mfma_f32_16x16x32_bf16 v[220:223], v[128:131], v[156:159], 0
  s_waitcnt lgkmcnt(3)
  v_mfma_f32_16x16x32_bf16 v[224:227], v[128:131], v[160:163], 0
  s_waitcnt lgkmcnt(2)
  v_mfma_f32_16x16x32_bf16 v[228:231], v[128:131], v[164:167], 0
  s_waitcnt lgkmcnt(1)
  v_mfma_f32_16x16x32_bf16 v[232:235], v[128:131], v[168:171], 0
  s_waitcnt lgkmcnt(0)
  v_mfma_f32_16x16x32_bf16 v[236:239], v[128:131], v[172:175], 0
  s_waitcnt vmcnt(6)
  s_cmp_ge_u32 s69, 2
  s_cbranch_scc1 L_ad66
  s_waitcnt vmcnt(5)
  s_cmp_ge_u32 s69, 1
  s_cbranch_scc1 L_ad66
  s_waitcnt vmcnt(4)
L_ad66:
  buffer_load_dwordx4 v7, s[36:39], s65 offen offset:1024 nt lds
  s_waitcnt vmcnt(6)
  s_cmp_ge_u32 s69, 2
  s_cbranch_scc1 L_ad67
  s_waitcnt vmcnt(5)
  s_cmp_ge_u32 s69, 1
  s_cbranch_scc1 L_ad67
  s_waitcnt vmcnt(4)
L_ad67:
  buffer_load_dwordx4 v6, s[36:39], s65 offen offset:2048 nt lds
  s_waitcnt vmcnt(6)
  s_cmp_ge_u32 s69, 2
  s_cbranch_scc1 L_ad68
  s_waitcnt vmcnt(5)
  s_cmp_ge_u32 s69, 1
  s_cbranch_scc1 L_ad68
  s_waitcnt vmcnt(4)
L_ad68:
  buffer_load_dwordx4 v7, s[36:39], s65 offen offset:3072 nt lds
  v_readfirstlane_b32 s69, v253
  ds_read_b32 v253, v254
  s_waitcnt vmcnt(6)
  s_cmp_ge_u32 s69, 2
  s_cbranch_scc1 L_ad69
  s_waitcnt vmcnt(5)
  s_cmp_ge_u32 s69, 1
  s_cbranch_scc1 L_ad69
  s_waitcnt vmcnt(4)
L_ad69:
  s_add_u32 m0, s64, 20480
  s_mov_b32 s65, 81920
  buffer_load_dwordx4 v6, s[36:39], s65 offen offset:0 nt lds
  ds_read_b64_tr_b16 v[176:177], v12 offset:8192
  ds_read_b64_tr_b16 v[180:181], v13 offset:8192
  ds_read_b64_tr_b16 v[184:185], v14 offset:8192
  ds_read_b64_tr_b16 v[188:189], v15 offset:8192
  ds_read_b64_tr_b16 v[192:193], v16 offset:8192
  ds_read_b64_tr_b16 v[196:197], v17 offset:8192
  ds_read_b64_tr_b16 v[200:201], v18 offset:8192
  ds_read_b64_tr_b16 v[204:205], v19 offset:8192
  v_mov_b32_dpp v244, v128 row_shl:4 row_mask:0xf bank_mask:0xf bound_ctrl:0
  v_mov_b32_dpp v245, v129 row_shl:4 row_mask:0xf bank_mask:0xf bound_ctrl:0
  v_mov_b32_dpp v246, v130 row_shl:4 row_mask:0xf bank_mask:0xf bound_ctrl:0
  v_mov_b32_dpp v247, v131 row_shl:4 row_mask:0xf bank_mask:0xf bound_ctrl:0
  s_waitcnt vmcnt(6)
  s_cmp_ge_u32 s69, 2
  s_cbranch_scc1 L_ad70
  s_waitcnt vmcnt(5)
  s_cmp_ge_u32 s69, 1
  s_cbranch_scc1 L_ad70
  s_waitcnt vmcnt(4)
L_ad70:
  buffer_load_dwordx4 v7, s[36:39], s65 offen offset:1024 nt lds
  s_waitcnt vmcnt(6)
  s_cmp_ge_u32 s69, 2
  s_cbranch_scc1 L_ad71
  s_waitcnt vmcnt(5)
  s_cmp_ge_u32 s69, 1
  s_cbranch_scc1 L_ad71
  s_waitcnt vmcnt(4)
L_ad71:
  buffer_load_dwordx4 v6, s[36:39], s65 offen offset:2048 nt lds
  s_waitcnt vmcnt(6)
  s_cmp_ge_u32 s69, 2
  s_cbranch_scc1 L_ad72
  s_waitcnt vmcnt(5)
  s_cmp_ge_u32 s69, 1
  s_cbranch_scc1 L_ad72
  s_waitcnt vmcnt(4)
L_ad72:
  buffer_load_dwordx4 v7, s[36:39], s65 offen offset:3072 nt lds
  s_waitcnt vmcnt(6)
  s_cmp_ge_u32 s69, 2
  s_cbranch_scc1 L_ad73
  s_waitcnt vmcnt(5)
  s_cmp_ge_u32 s69, 1
  s_cbranch_scc1 L_ad73
  s_waitcnt vmcnt(4)
L_ad73:
  s_add_u32 m0, s64, 24576
  s_mov_b32 s65, 98304
  buffer_load_dwordx4 v6, s[36:39], s65 offen offset:0 nt lds
  ds_read_b64_tr_b16 v[178:179], v12 offset:12288
  ds_read_b64_tr_b16 v[182:183], v13 offset:12288
  ds_read_b64_tr_b16 v[186:187], v14 offset:12288
  ds_read_b64_tr_b16 v[190:191], v15 offset:12288
  ds_read_b64_tr_b16 v[194:195], v16 offset:12288
  ds_read_b64_tr_b16 v[198:199], v17 offset:12288
  ds_read_b64_tr_b16 v[202:203], v18 offset:12288
  ds_read_b64_tr_b16 v[206:207], v19 offset:12288
  s_waitcnt lgkmcnt(7)
  v_mfma_f32_16x16x32_bf16 v[208:211], v[244:247], v[176:179], v[208:211]
  s_waitcnt lgkmcnt(6)
  v_mfma_f32_16x16x32_bf16 v[212:215], v[244:247], v[180:183], v[212:215]
  s_waitcnt lgkmcnt(5)
  v_mfma_f32_16x16x32_bf16 v[216:219], v[244:247], v[184:187], v[216:219]
  s_waitcnt lgkmcnt(4)
  v_mfma_f32_16x16x32_bf16 v[220:223], v[244:247], v[188:191], v[220:223]
  s_waitcnt lgkmcnt(3)
  v_mfma_f32_16x16x32_bf16 v[224:227], v[244:247], v[192:195], v[224:227]
  s_waitcnt lgkmcnt(2)
  v_mfma_f32_16x16x32_bf16 v[228:231], v[244:247], v[196:199], v[228:231]
  s_waitcnt lgkmcnt(1)
  v_mfma_f32_16x16x32_bf16 v[232:235], v[244:247], v[200:203], v[232:235]
  s_waitcnt lgkmcnt(0)
  v_mfma_f32_16x16x32_bf16 v[236:239], v[244:247], v[204:207], v[236:239]
  s_waitcnt vmcnt(6)
  s_cmp_ge_u32 s69, 2
  s_cbranch_scc1 L_ad74
  s_waitcnt vmcnt(5)
  s_cmp_ge_u32 s69, 1
  s_cbranch_scc1 L_ad74
  s_waitcnt vmcnt(4)
L_ad74:
  buffer_load_dwordx4 v7, s[36:39], s65 offen offset:1024 nt lds
  s_waitcnt vmcnt(6)
  s_cmp_ge_u32 s69, 2
  s_cbranch_scc1 L_ad75
  s_waitcnt vmcnt(5)
  s_cmp_ge_u32 s69, 1
  s_cbranch_scc1 L_ad75
  s_waitcnt vmcnt(4)
L_ad75:
  buffer_load_dwordx4 v6, s[36:39], s65 offen offset:2048 nt lds
  s_waitcnt vmcnt(6)
  s_cmp_ge_u32 s69, 2
  s_cbranch_scc1 L_ad76
  s_waitcnt vmcnt(5)
  s_cmp_ge_u32 s69, 1
  s_cbranch_scc1 L_ad76
  s_waitcnt vmcnt(4)
L_ad76:
  buffer_load_dwordx4 v7, s[36:39], s65 offen offset:3072 nt lds
  v_readfirstlane_b32 s69, v253
  ds_read_b32 v253, v254
  s_cmp_lg_u32 s3, 0
  s_cbranch_scc1 L_ck77
  s_memrealtime s[84:85]
  s_waitcnt lgkmcnt(0)
  v_mov_b32 v26, 4
  v_mov_b32 v27, s84
  s_mov_b64 exec, 1
  ds_write_b64 v255, v[26:27]
  s_mov_b64 exec, -1
L_ck77:
  s_waitcnt vmcnt(6)
  s_cmp_ge_u32 s69, 2
  s_cbranch_scc1 L_ad78
  s_waitcnt vmcnt(5)
  s_cmp_ge_u32 s69, 1
  s_cbranch_scc1 L_ad78
  s_waitcnt vmcnt(4)
L_ad78:
  s_add_u32 m0, s64, 28672
  s_mov_b32 s65, 114688
  buffer_load_dwordx4 v6, s[36:39], s65 offen offset:0 nt lds
  ds_read_b64_tr_b16 v[144:145], v12 offset:16384
  ds_read_b64_tr_b16 v[148:149], v13 offset:16384
  ds_read_b64_tr_b16 v[152:153], v14 offset:16384
  ds_read_b64_tr_b16 v[156:157], v15 offset:16384
  ds_read_b64_tr_b16 v[160:161], v16 offset:16384
  ds_read_b64_tr_b16 v[164:165], v17 offset:16384
  ds_read_b64_tr_b16 v[168:169], v18 offset:16384
  ds_read_b64_tr_b16 v[172:173], v19 offset:16384
  v_mov_b32_dpp v240, v128 row_shl:8 row_mask:0xf bank_mask:0xf bound_ctrl:0
  v_mov_b32_dpp v241, v129 row_shl:8 row_mask:0xf bank_mask:0xf bound_ctrl:0
  v_mov_b32_dpp v242, v130 row_shl:8 row_mask:0xf bank_mask:0xf bound_ctrl:0
  v_mov_b32_dpp v243, v131 row_shl:8 row_mask:0xf bank_mask:0xf bound_ctrl:0
  s_waitcnt vmcnt(6)
  s_cmp_ge_u32 s69, 2
  s_cbranch_scc1 L_ad79
  s_waitcnt vmcnt(5)
  s_cmp_ge_u32 s69, 1
  s_cbranch_scc1 L_ad79
  s_waitcnt vmcnt(4)
L_ad79:
  buffer_load_dwordx4 v7, s[36:39], s65 offen offset:1024 nt lds
  s_waitcnt vmcnt(6)
  s_cmp_ge_u32 s69, 2
  s_cbranch_scc1 L_ad80
  s_waitcnt vmcnt(5)
  s_cmp_ge_u32 s69, 1
  s_cbranch_scc1 L_ad80
  s_waitcnt vmcnt(4)
L_ad80:
  buffer_load_dwordx4 v6, s[36:39], s65 offen offset:2048 nt lds
  s_waitcnt vmcnt(6)
  s_cmp_ge_u32 s69, 2
  s_cbranch_scc1 L_ad81
  s_waitcnt vmcnt(5)
  s_cmp_ge_u32 s69, 1
  s_cbranch_scc1 L_ad81
  s_waitcnt vmcnt(4)
L_ad81:
  buffer_load_dwordx4 v7, s[36:39], s65 offen offset:3072 nt lds
  s_waitcnt vmcnt(6)
  s_cmp_ge_u32 s69, 2
  s_cbranch_scc1 L_ad82
  s_waitcnt vmcnt(5)
  s_cmp_ge_u32 s69, 1
  s_cbranch_scc1 L_ad82
  s_waitcnt vmcnt(4)
L_ad82:
  s_add_u32 m0, s64, 0
  s_mov_b32 s65, 131072
  buffer_load_dwordx4 v6, s[36:39], s65 offen offset:0 nt lds
  ds_read_b64_tr_b16 v[146:147], v12 offset:20480
  ds_read_b64_tr_b16 v[150:151], v13 offset:20480
  ds_read_b64_tr_b16 v[154:155], v14 offset:20480
  ds_read_b64_tr_b16 v[158:159], v15 offset:20480
  ds_read_b64_tr_b16 v[162:163], v16 offset:20480
  ds_read_b64_tr_b16 v[166:167], v17 offset:20480
  ds_read_b64_tr_b16 v[170:171], v18 offset:20480
  ds_read_b64_tr_b16 v[174:175], v19 offset:20480
  s_waitcnt lgkmcnt(7)
  v_mfma_f32_16x16x32_bf16 v[208:211], v[240:243], v[144:147], v[208:211]
  s_waitcnt lgkmcnt(6)
  v_mfma_f32_16x16x32_bf16 v[212:215], v[240:243], v[148:151], v[212:215]
  s_waitcnt lgkmcnt(5)
  v_mfma_f32_16x16x32_bf16 v[216:219], v[240:243], v[152:155], v[216:219]
  s_waitcnt lgkmcnt(4)
  v_mfma_f32_16x16x32_bf16 v[220:223], v[240:243], v[156:159], v[220:223]
  s_waitcnt lgkmcnt(3)
  v_mfma_f32_16x16x32_bf16 v[224:227], v[240:243], v[160:163], v[224:227]
  s_waitcnt lgkmcnt(2)
  v_mfma_f32_16x16x32_bf16 v[228:231], v[240:243], v[164:167], v[228:231]
  s_waitcnt lgkmcnt(1)
  v_mfma_f32_16x16x32_bf16 v[232:235], v[240:243], v[168:171], v[232:235]
  s_waitcnt lgkmcnt(0)
  v_mfma_f32_16x16x32_bf16 v[236:239], v[240:243], v[172:175], v[236:239]
  s_waitcnt vmcnt(6)
  s_cmp_ge_u32 s69, 2
  s_cbranch_scc1 L_ad83
  s_waitcnt vmcnt(5)
  s_cmp_ge_u32 s69, 1
  s_cbranch_scc1 L_ad83
  s_waitcnt vmcnt(4)
L_ad83:
  buffer_load_dwordx4 v7, s[36:39], s65 offen offset:1024 nt lds
  s_waitcnt vmcnt(6)
  s_cmp_ge_u32 s69, 2
  s_cbranch_scc1 L_ad84
  s_waitcnt vmcnt(5)
  s_cmp_ge_u32 s69, 1
  s_cbranch_scc1 L_ad84
  s_waitcnt vmcnt(4)
L_ad84:
  buffer_load_dwordx4 v6, s[36:39], s65 offen offset:2048 nt lds
  s_waitcnt vmcnt(6)
  s_cmp_ge_u32 s69, 2
  s_cbranch_scc1 L_ad85
  s_waitcnt vmcnt(5)
  s_cmp_ge_u32 s69, 1
  s_cbranch_scc1 L_ad85
  s_waitcnt vmcnt(4)
L_ad85:
  buffer_load_dwordx4 v7, s[36:39], s65 offen offset:3072 nt lds
  v_readfirstlane_b32 s69, v253
  ds_read_b32 v253, v254
  s_waitcnt vmcnt(6)
  s_cmp_ge_u32 s69, 2
  s_cbranch_scc1 L_ad86
  s_waitcnt vmcnt(5)
  s_cmp_ge_u32 s69, 1
  s_cbranch_scc1 L_ad86
  s_waitcnt vmcnt(4)
L_ad86:
  s_add_u32 m0, s64, 4096
  s_mov_b32 s65, 147456
  buffer_load_dwordx4 v6, s[36:39], s65 offen offset:0 nt lds
  ds_read_b64_tr_b16 v[176:177], v12 offset:24576
  ds_read_b64_tr_b16 v[180:181], v13 offset:24576
  ds_read_b64_tr_b16 v[184:185], v14 offset:24576
  ds_read_b64_tr_b16 v[188:189], v15 offset:24576
  ds_read_b64_tr_b16 v[192:193], v16 offset:24576
  ds_read_b64_tr_b16 v[196:197], v17 offset:24576
  ds_read_b64_tr_b16 v[200:201], v18 offset:24576
  ds_read_b64_tr_b16 v[204:205], v19 offset:24576
  v_mov_b32_dpp v244, v128 row_shl:12 row_mask:0xf bank_mask:0xf bound_ctrl:0
  v_mov_b32_dpp v245, v129 row_shl:12 row_mask:0xf bank_mask:0xf bound_ctrl:0
  v_mov_b32_dpp v246, v130 row_shl:12 row_mask:0xf bank_mask:0xf bound_ctrl:0
  v_mov_b32_dpp v247, v131 row_shl:12 row_mask:0xf bank_mask:0xf bound_ctrl:0
  s_waitcnt vmcnt(6)
  s_cmp_ge_u32 s69, 2
  s_cbranch_scc1 L_ad87
  s_waitcnt vmcnt(5)
  s_cmp_ge_u32 s69, 1
  s_cbranch_scc1 L_ad87
  s_waitcnt vmcnt(4)
L_ad87:
  buffer_load_dwordx4 v7, s[36:39], s65 offen offset:1024 nt lds
  s_waitcnt vmcnt(6)
  s_cmp_ge_u32 s69, 2
  s_cbranch_scc1 L_ad88
  s_waitcnt vmcnt(5)
  s_cmp_ge_u32 s69, 1
  s_cbranch_scc1 L_ad88
  s_waitcnt vmcnt(4)
L_ad88:
  buffer_load_dwordx4 v6, s[36:39], s65 offen offset:2048 nt lds
  s_waitcnt vmcnt(6)
  s_cmp_ge_u32 s69, 2
  s_cbranch_scc1 L_ad89
  s_waitcnt vmcnt(5)
  s_cmp_ge_u32 s69, 1
  s_cbranch_scc1 L_ad89
  s_waitcnt vmcnt(4)
L_ad89:
  buffer_load_dwordx4 v7, s[36:39], s65 offen offset:3072 nt lds
  s_waitcnt vmcnt(6)
  s_cmp_ge_u32 s69, 2
  s_cbranch_scc1 L_ad90
  s_waitcnt vmcnt(5)
  s_cmp_ge_u32 s69, 1
  s_cbranch_scc1 L_ad90
  s_waitcnt vmcnt(4)
L_ad90:
  s_add_u32 m0, s64, 8192
  s_mov_b32 s65, 163840
  buffer_load_dwordx4 v6, s[36:39], s65 offen offset:0 nt lds
  ds_read_b64_tr_b16 v[178:179], v12 offset:28672
  ds_read_b64_tr_b16 v[182:183], v13 offset:28672
  ds_read_b64_tr_b16 v[186:187], v14 offset:28672
  ds_read_b64_tr_b16 v[190:191], v15 offset:28672
  ds_read_b64_tr_b16 v[194:195], v16 offset:28672
  ds_read_b64_tr_b16 v[198:199], v17 offset:28672
  ds_read_b64_tr_b16 v[202:203], v18 offset:28672
  ds_read_b64_tr_b16 v[206:207], v19 offset:28672
  s_waitcnt lgkmcnt(7)
  v_mfma_f32_16x16x32_bf16 v[208:211], v[244:247], v[176:179], v[208:211]
  s_waitcnt lgkmcnt(6)
  v_mfma_f32_16x16x32_bf16 v[212:215], v[244:247], v[180:183], v[212:215]
  s_waitcnt lgkmcnt(5)
  v_mfma_f32_16x16x32_bf16 v[216:219], v[244:247], v[184:187], v[216:219]
  s_waitcnt lgkmcnt(4)
  v_mfma_f32_16x16x32_bf16 v[220:223], v[244:247], v[188:191], v[220:223]
  s_waitcnt lgkmcnt(3)
  v_mfma_f32_16x16x32_bf16 v[224:227], v[244:247], v[192:195], v[224:227]
  s_waitcnt lgkmcnt(2)
  v_mfma_f32_16x16x32_bf16 v[228:231], v[244:247], v[196:199], v[228:231]
  s_waitcnt lgkmcnt(1)
  v_mfma_f32_16x16x32_bf16 v[232:235], v[244:247], v[200:203], v[232:235]
  s_waitcnt lgkmcnt(0)
  v_mfma_f32_16x16x32_bf16 v[236:239], v[244:247], v[204:207], v[236:239]
  s_waitcnt vmcnt(6)
  s_cmp_ge_u32 s69, 2
  s_cbranch_scc1 L_ad91
  s_waitcnt vmcnt(5)
  s_cmp_ge_u32 s69, 1
  s_cbranch_scc1 L_ad91
  s_waitcnt vmcnt(4)
L_ad91:
  buffer_load_dwordx4 v7, s[36:39], s65 offen offset:1024 nt lds
  s_waitcnt vmcnt(6)
  s_cmp_ge_u32 s69, 2
  s_cbranch_scc1 L_ad92
  s_waitcnt vmcnt(5)
  s_cmp_ge_u32 s69, 1
  s_cbranch_scc1 L_ad92
  s_waitcnt vmcnt(4)
L_ad92:
  buffer_load_dwordx4 v6, s[36:39], s65 offen offset:2048 nt lds
  s_waitcnt vmcnt(6)
  s_cmp_ge_u32 s69, 2
  s_cbranch_scc1 L_ad93
  s_waitcnt vmcnt(5)
  s_cmp_ge_u32 s69, 1
  s_cbranch_scc1 L_ad93
  s_waitcnt vmcnt(4)
L_ad93:
  buffer_load_dwordx4 v7, s[36:39], s65 offen offset:3072 nt lds
  v_readfirstlane_b32 s69, v253
  ds_read_b32 v253, v254
  s_waitcnt vmcnt(6)
  s_cmp_ge_u32 s69, 2
  s_cbranch_scc1 L_ad94
  s_waitcnt vmcnt(5)
  s_cmp_ge_u32 s69, 1
  s_cbranch_scc1 L_ad94
  s_waitcnt vmcnt(4)
L_ad94:
  s_add_u32 m0, s64, 12288
  s_mov_b32 s65, 180224
  buffer_load_dwordx4 v6, s[36:39], s65 offen offset:0 nt lds
  ds_read_b64_tr_b16 v[144:145], v12 offset:0
  ds_read_b64_tr_b16 v[148:149], v13 offset:0
  ds_read_b64_tr_b16 v[152:153], v14 offset:0
  ds_read_b64_tr_b16 v[156:157], v15 offset:0
  ds_read_b64_tr_b16 v[160:161], v16 offset:0
  ds_read_b64_tr_b16 v[164:165], v17 offset:0
  ds_read_b64_tr_b16 v[168:169], v18 offset:0
  ds_read_b64_tr_b16 v[172:173], v19 offset:0
  s_waitcnt vmcnt(6)
  s_cmp_ge_u32 s69, 2
  s_cbranch_scc1 L_ad95
  s_waitcnt vmcnt(5)
  s_cmp_ge_u32 s69, 1
  s_cbranch_scc1 L_ad95
  s_waitcnt vmcnt(4)
L_ad95:
  buffer_load_dwordx4 v7, s[36:39], s65 offen offset:1024 nt lds
  s_waitcnt vmcnt(6)
  s_cmp_ge_u32 s69, 2
  s_cbranch_scc1 L_ad96
  s_waitcnt vmcnt(5)
  s_cmp_ge_u32 s69, 1
  s_cbranch_scc1 L_ad96
  s_waitcnt vmcnt(4)
L_ad96:
  buffer_load_dwordx4 v6, s[36:39], s65 offen offset:2048 nt lds
  s_waitcnt vmcnt(6)
  s_cmp_ge_u32 s69, 2
  s_cbranch_scc1 L_ad97
  s_waitcnt vmcnt(5)
  s_cmp_ge_u32 s69, 1
  s_cbranch_scc1 L_ad97
  s_waitcnt vmcnt(4)
L_ad97:
  buffer_load_dwordx4 v7, s[36:39], s65 offen offset:3072 nt lds
  s_waitcnt vmcnt(6)
  s_cmp_ge_u32 s69, 2
  s_cbranch_scc1 L_ad98
  s_waitcnt vmcnt(5)
  s_cmp_ge_u32 s69, 1
  s_cbranch_scc1 L_ad98
  s_waitcnt vmcnt(4)
L_ad98:
  s_add_u32 m0, s64, 16384
  s_mov_b32 s65, 196608
  buffer_load_dwordx4 v6, s[36:39], s65 offen offset:0 nt lds
  ds_read_b64_tr_b16 v[146:147], v12 offset:4096
  ds_read_b64_tr_b16 v[150:151], v13 offset:4096
  ds_read_b64_tr_b16 v[154:155], v14 offset:4096
  ds_read_b64_tr_b16 v[158:159], v15 offset:4096
  ds_read_b64_tr_b16 v[162:163], v16 offset:4096
  ds_read_b64_tr_b16 v[166:167], v17 offset:4096
  ds_read_b64_tr_b16 v[170:171], v18 offset:4096
  ds_read_b64_tr_b16 v[174:175], v19 offset:4096
  s_waitcnt lgkmcnt(7)
  v_mfma_f32_16x16x32_bf16 v[208:211], v[132:135], v[144:147], v[208:211]
  s_waitcnt lgkmcnt(6)
  v_mfma_f32_16x16x32_bf16 v[212:215], v[132:135], v[148:151], v[212:215]
  s_waitcnt lgkmcnt(5)
  v_mfma_f32_16x16x32_bf16 v[216:219], v[132:135], v[152:155], v[216:219]
  s_waitcnt lgkmcnt(4)
  v_mfma_f32_16x16x32_bf16 v[220:223], v[132:135], v[156:159], v[220:223]
  s_waitcnt lgkmcnt(3)
  v_mfma_f32_16x16x32_bf16 v[224:227], v[132:135], v[160:163], v[224:227]
  s_waitcnt lgkmcnt(2)
  v_mfma_f32_16x16x32_bf16 v[228:231], v[132:135], v[164:167], v[228:231]
  s_waitcnt lgkmcnt(1)
  v_mfma_f32_16x16x32_bf16 v[232:235], v[132:135], v[168:171], v[232:235]
  s_waitcnt lgkmcnt(0)
  v_mfma_f32_16x16x32_bf16 v[236:239], v[132:135], v[172:175], v[236:239]
  s_waitcnt vmcnt(6)
  s_cmp_ge_u32 s69, 2
  s_cbranch_scc1 L_ad99
  s_waitcnt vmcnt(5)
  s_cmp_ge_u32 s69, 1
  s_cbranch_scc1 L_ad99
  s_waitcnt vmcnt(4)
L_ad99:
  buffer_load_dwordx4 v7, s[36:39], s65 offen offset:1024 nt lds
  s_waitcnt vmcnt(6)
  s_cmp_ge_u32 s69, 2
  s_cbranch_scc1 L_ad100
  s_waitcnt vmcnt(5)
  s_cmp_ge_u32 s69, 1
  s_cbranch_scc1 L_ad100
  s_waitcnt vmcnt(4)
L_ad100:
  buffer_load_dwordx4 v6, s[36:39], s65 offen offset:2048 nt lds
  s_waitcnt vmcnt(6)
  s_cmp_ge_u32 s69, 2
  s_cbranch_scc1 L_ad101
  s_waitcnt vmcnt(5)
  s_cmp_ge_u32 s69, 1
  s_cbranch_scc1 L_ad101
  s_waitcnt vmcnt(4)
L_ad101:
  buffer_load_dwordx4 v7, s[36:39], s65 offen offset:3072 nt lds
  v_readfirstlane_b32 s69, v253
  ds_read_b32 v253, v254
  s_cmp_lg_u32 s3, 0
  s_cbranch_scc1 L_ck102
  s_memrealtime s[84:85]
  s_waitcnt lgkmcnt(0)
  v_mov_b32 v26, 5
  v_mov_b32 v27, s84
  s_mov_b64 exec, 1
  ds_write_b64 v255, v[26:27]
  s_mov_b64 exec, -1
L_ck102:
  s_waitcnt vmcnt(6)
  s_cmp_ge_u32 s69, 2
  s_cbranch_scc1 L_ad103
  s_waitcnt vmcnt(5)
  s_cmp_ge_u32 s69, 1
  s_cbranch_scc1 L_ad103
  s_waitcnt vmcnt(4)
L_ad103:
  s_add_u32 m0, s64, 20480
  s_mov_b32 s65, 212992
  buffer_load_dwordx4 v6, s[36:39], s65 offen offset:0 nt lds
  ds_read_b64_tr_b16 v[176:177], v12 offset:8192
  ds_read_b64_tr_b16 v[180:181], v13 offset:8192
  ds_read_b64_tr_b16 v[184:185], v14 offset:8192
  ds_read_b64_tr_b16 v[188:189], v15 offset:8192
  ds_read_b64_tr_b16 v[192:193], v16 offset:8192
  ds_read_b64_tr_b16 v[196:197], v17 offset:8192
  ds_read_b64_tr_b16 v[200:201], v18 offset:8192
  ds_read_b64_tr_b16 v[204:205], v19 offset:8192
  v_mov_b32_dpp v244, v132 row_shl:4 row_mask:0xf bank_mask:0xf bound_ctrl:0
  v_mov_b32_dpp v245, v133 row_shl:4 row_mask:0xf bank_mask:0xf bound_ctrl:0
  v_mov_b32_dpp v246, v134 row_shl:4 row_mask:0xf bank_mask:0xf bound_ctrl:0
  v_mov_b32_dpp v247, v135 row_shl:4 row_mask:0xf bank_mask:0xf bound_ctrl:0
  s_waitcnt vmcnt(6)
  s_cmp_ge_u32 s69, 2
  s_cbranch_scc1 L_ad104
  s_waitcnt vmcnt(5)
  s_cmp_ge_u32 s69, 1
  s_cbranch_scc1 L_ad104
  s_waitcnt vmcnt(4)
L_ad104:
  buffer_load_dwordx4 v7, s[36:39], s65 offen offset:1024 nt lds
  s_waitcnt vmcnt(6)
  s_cmp_ge_u32 s69, 2
  s_cbranch_scc1 L_ad105
  s_waitcnt vmcnt(5)
  s_cmp_ge_u32 s69, 1
  s_cbranch_scc1 L_ad105
  s_waitcnt vmcnt(4)
L_ad105:
  buffer_load_dwordx4 v6, s[36:39], s65 offen offset:2048 nt lds
  s_waitcnt vmcnt(6)
  s_cmp_ge_u32 s69, 2
  s_cbranch_scc1 L_ad106
  s_waitcnt vmcnt(5)
  s_cmp_ge_u32 s69, 1
  s_cbranch_scc1 L_ad106
  s_waitcnt vmcnt(4)
L_ad106:
  buffer_load_dwordx4 v7, s[36:39], s65 offen offset:3072 nt lds
  s_waitcnt vmcnt(6)
  s_cmp_ge_u32 s69, 2
  s_cbranch_scc1 L_ad107
  s_waitcnt vmcnt(5)
  s_cmp_ge_u32 s69, 1
  s_cbranch_scc1 L_ad107
  s_waitcnt vmcnt(4)
L_ad107:
  s_add_u32 m0, s64, 24576
  s_mov_b32 s65, 229376
  buffer_load_dwordx4 v6, s[36:39], s65 offen offset:0 nt lds
  ds_read_b64_tr_b16 v[178:179], v12 offset:12288
  ds_read_b64_tr_b16 v[182:183], v13 offset:12288
  ds_read_b64_tr_b16 v[186:187], v14 offset:12288
  ds_read_b64_tr_b16 v[190:191], v15 offset:12288
  ds_read_b64_tr_b16 v[194:195], v16 offset:12288
  ds_read_b64_tr_b16 v[198:199], v17 offset:12288
  ds_read_b64_tr_b16 v[202:203], v18 offset:12288
  ds_read_b64_tr_b16 v[206:207], v19 offset:12288
  s_waitcnt lgkmcnt(7)
  v_mfma_f32_16x16x32_bf16 v[208:211], v[244:247], v[176:179], v[208:211]
  s_waitcnt lgkmcnt(6)
  v_mfma_f32_16x16x32_bf16 v[212:215], v[244:247], v[180:183], v[212:215]
  s_waitcnt lgkmcnt(5)
  v_mfma_f32_16x16x32_bf16 v[216:219], v[244:247], v[184:187], v[216:219]
  s_waitcnt lgkmcnt(4)
  v_mfma_f32_16x16x32_bf16 v[220:223], v[244:247], v[188:191], v[220:223]
  s_waitcnt lgkmcnt(3)
  v_mfma_f32_16x16x32_bf16 v[224:227], v[244:247], v[192:195], v[224:227]
  s_waitcnt lgkmcnt(2)
  v_mfma_f32_16x16x32_bf16 v[228:231], v[244:247], v[196:199], v[228:231]
  s_waitcnt lgkmcnt(1)
  v_mfma_f32_16x16x32_bf16 v[232:235], v[244:247], v[200:203], v[232:235]
  s_waitcnt lgkmcnt(0)
  v_mfma_f32_16x16x32_bf16 v[236:239], v[244:247], v[204:207], v[236:239]
  s_waitcnt vmcnt(6)
  s_cmp_ge_u32 s69, 2
  s_cbranch_scc1 L_ad108
  s_waitcnt vmcnt(5)
  s_cmp_ge_u32 s69, 1
  s_cbranch_scc1 L_ad108
  s_waitcnt vmcnt(4)
L_ad108:
  buffer_load_dwordx4 v7, s[36:39], s65 offen offset:1024 nt lds
  s_waitcnt vmcnt(6)
  s_cmp_ge_u32 s69, 2
  s_cbranch_scc1 L_ad109
  s_waitcnt vmcnt(5)
  s_cmp_ge_u32 s69, 1
  s_cbranch_scc1 L_ad109
  s_waitcnt vmcnt(4)
L_ad109:
  buffer_load_dwordx4 v6, s[36:39], s65 offen offset:2048 nt lds
  s_waitcnt vmcnt(6)
  s_cmp_ge_u32 s69, 2
  s_cbranch_scc1 L_ad110
  s_waitcnt vmcnt(5)
  s_cmp_ge_u32 s69, 1
  s_cbranch_scc1 L_ad110
  s_waitcnt vmcnt(4)
L_ad110:
  buffer_load_dwordx4 v7, s[36:39], s65 offen offset:3072 nt lds
  v_readfirstlane_b32 s69, v253
  ds_read_b32 v253, v254
  s_waitcnt vmcnt(6)
  s_cmp_ge_u32 s69, 2
  s_cbranch_scc1 L_ad111
  s_waitcnt vmcnt(5)
  s_cmp_ge_u32 s69, 1
  s_cbranch_scc1 L_ad111
  s_waitcnt vmcnt(4)
L_ad111:
  s_add_u32 m0, s64, 28672
  s_mov_b32 s65, 245760
  buffer_load_dwordx4 v6, s[36:39], s65 offen offset:0 nt lds
  ds_read_b64_tr_b16 v[144:145], v12 offset:16384
  ds_read_b64_tr_b16 v[148:149], v13 offset:16384
  ds_read_b64_tr_b16 v[152:153], v14 offset:16384
  ds_read_b64_tr_b16 v[156:157], v15 offset:16384
  ds_read_b64_tr_b16 v[160:161], v16 offset:16384
  ds_read_b64_tr_b16 v[164:165], v17 offset:16384
  ds_read_b64_tr_b16 v[168:169], v18 offset:16384
  ds_read_b64_tr_b16 v[172:173], v19 offset:16384
  v_mov_b32_dpp v240, v132 row_shl:8 row_mask:0xf bank_mask:0xf bound_ctrl:0
  v_mov_b32_dpp v241, v133 row_shl:8 row_mask:0xf bank_mask:0xf bound_ctrl:0
  v_mov_b32_dpp v242, v134 row_shl:8 row_mask:0xf bank_mask:0xf bound_ctrl:0
  v_mov_b32_dpp v243, v135 row_shl:8 row_mask:0xf bank_mask:0xf bound_ctrl:0
  s_waitcnt vmcnt(6)
  s_cmp_ge_u32 s69, 2
  s_cbranch_scc1 L_ad112
  s_waitcnt vmcnt(5)
  s_cmp_ge_u32 s69, 1
  s_cbranch_scc1 L_ad112
  s_waitcnt vmcnt(4)
L_ad112:
  buffer_load_dwordx4 v7, s[36:39], s65 offen offset:1024 nt lds
  s_waitcnt vmcnt(6)
  s_cmp_ge_u32 s69, 2
  s_cbranch_scc1 L_ad113
  s_waitcnt vmcnt(5)
  s_cmp_ge_u32 s69, 1
  s_cbranch_scc1 L_ad113
  s_waitcnt vmcnt(4)
L_ad113:
  buffer_load_dwordx4 v6, s[36:39], s65 offen offset:2048 nt lds
  s_waitcnt vmcnt(6)
  s_cmp_ge_u32 s69, 2
  s_cbranch_scc1 L_ad114
  s_waitcnt vmcnt(5)
  s_cmp_ge_u32 s69, 1
  s_cbranch_scc1 L_ad114
  s_waitcnt vmcnt(4)
L_ad114:
  buffer_load_dwordx4 v7, s[36:39], s65 offen offset:3072 nt lds
  s_waitcnt vmcnt(6)
  s_cmp_ge_u32 s69, 2
  s_cbranch_scc1 L_ad115
  s_waitcnt vmcnt(5)
  s_cmp_ge_u32 s69, 1
  s_cbranch_scc1 L_ad115
  s_waitcnt vmcnt(4)
L_ad115:
  s_add_u32 m0, s64, 0
  s_mov_b32 s65, 262144
  buffer_load_dwordx4 v6, s[36:39], s65 offen offset:0 nt lds
  ds_read_b64_tr_b16 v[146:147], v12 offset:20480
  ds_read_b64_tr_b16 v[150:151], v13 offset:20480
  ds_read_b64_tr_b16 v[154:155], v14 offset:20480
  ds_read_b64_tr_b16 v[158:159], v15 offset:20480
  ds_read_b64_tr_b16 v[162:163], v16 offset:20480
  ds_read_b64_tr_b16 v[166:167], v17 offset:20480
  ds_read_b64_tr_b16 v[170:171], v18 offset:20480
  ds_read_b64_tr_b16 v[174:175], v19 offset:20480
  s_waitcnt lgkmcnt(7)
  v_mfma_f32_16x16x32_bf16 v[208:211], v[240:243], v[144:147], v[208:211]
  s_waitcnt lgkmcnt(6)
  v_mfma_f32_16x16x32_bf16 v[212:215], v[240:243], v[148:151], v[212:215]
  s_waitcnt lgkmcnt(5)
  v_mfma_f32_16x16x32_bf16 v[216:219], v[240:243], v[152:155], v[216:219]
  s_waitcnt lgkmcnt(4)
  v_mfma_f32_16x16x32_bf16 v[220:223], v[240:243], v[156:159], v[220:223]
  s_waitcnt lgkmcnt(3)
  v_mfma_f32_16x16x32_bf16 v[224:227], v[240:243], v[160:163], v[224:227]
  s_waitcnt lgkmcnt(2)
  v_mfma_f32_16x16x32_bf16 v[228:231], v[240:243], v[164:167], v[228:231]
  s_waitcnt lgkmcnt(1)
  v_mfma_f32_16x16x32_bf16 v[232:235], v[240:243], v[168:171], v[232:235]
  s_waitcnt lgkmcnt(0)
  v_mfma_f32_16x16x32_bf16 v[236:239], v[240:243], v[172:175], v[236:239]
  s_waitcnt vmcnt(6)
  s_cmp_ge_u32 s69, 2
  s_cbranch_scc1 L_ad116
  s_waitcnt vmcnt(5)
  s_cmp_ge_u32 s69, 1
  s_cbranch_scc1 L_ad116
  s_waitcnt vmcnt(4)
L_ad116:
  buffer_load_dwordx4 v7, s[36:39], s65 offen offset:1024 nt lds
  s_waitcnt vmcnt(6)
  s_cmp_ge_u32 s69, 2
  s_cbranch_scc1 L_ad117
  s_waitcnt vmcnt(5)
  s_cmp_ge_u32 s69, 1
  s_cbranch_scc1 L_ad117
  s_waitcnt vmcnt(4)
L_ad117:
  buffer_load_dwordx4 v6, s[36:39], s65 offen offset:2048 nt lds
  s_waitcnt vmcnt(6)
  s_cmp_ge_u32 s69, 2
  s_cbranch_scc1 L_ad118
  s_waitcnt vmcnt(5)
  s_cmp_ge_u32 s69, 1
  s_cbranch_scc1 L_ad118
  s_waitcnt vmcnt(4)
L_ad118:
  buffer_load_dwordx4 v7, s[36:39], s65 offen offset:3072 nt lds
  v_readfirstlane_b32 s69, v253
  ds_read_b32 v253, v254
  s_waitcnt vmcnt(6)
  s_cmp_ge_u32 s69, 2
  s_cbranch_scc1 L_ad119
  s_waitcnt vmcnt(5)
  s_cmp_ge_u32 s69, 1
  s_cbranch_scc1 L_ad119
  s_waitcnt vmcnt(4)
L_ad119:
  s_add_u32 m0, s64, 4096
  s_mov_b32 s65, 278528
  buffer_load_dwordx4 v6, s[36:39], s65 offen offset:0 nt lds
  ds_read_b64_tr_b16 v[176:177], v12 offset:24576
  ds_read_b64_tr_b16 v[180:181], v13 offset:24576
  ds_read_b64_tr_b16 v[184:185], v14 offset:24576
  ds_read_b64_tr_b16 v[188:189], v15 offset:24576
  ds_read_b64_tr_b16 v[192:193], v16 offset:24576
  ds_read_b64_tr_b16 v[196:197], v17 offset:24576
  ds_read_b64_tr_b16 v[200:201], v18 offset:24576
  ds_read_b64_tr_b16 v[204:205], v19 offset:24576
  v_mov_b32_dpp v244, v132 row_shl:12 row_mask:0xf bank_mask:0xf bound_ctrl:0
  v_mov_b32_dpp v245, v133 row_shl:12 row_mask:0xf bank_mask:0xf bound_ctrl:0
  v_mov_b32_dpp v246, v134 row_shl:12 row_mask:0xf bank_mask:0xf bound_ctrl:0
  v_mov_b32_dpp v247, v135 row_shl:12 row_mask:0xf bank_mask:0xf bound_ctrl:0
  s_waitcnt vmcnt(6)
  s_cmp_ge_u32 s69, 2
  s_cbranch_scc1 L_ad120
  s_waitcnt vmcnt(5)
  s_cmp_ge_u32 s69, 1
  s_cbranch_scc1 L_ad120
  s_waitcnt vmcnt(4)
L_ad120:
  buffer_load_dwordx4 v7, s[36:39], s65 offen offset:1024 nt lds
  s_waitcnt vmcnt(6)
  s_cmp_ge_u32 s69, 2
  s_cbranch_scc1 L_ad121
  s_waitcnt vmcnt(5)
  s_cmp_ge_u32 s69, 1
  s_cbranch_scc1 L_ad121
  s_waitcnt vmcnt(4)
L_ad121:
  buffer_load_dwordx4 v6, s[36:39], s65 offen offset:2048 nt lds
  s_waitcnt vmcnt(6)
  s_cmp_ge_u32 s69, 2
  s_cbranch_scc1 L_ad122
  s_waitcnt vmcnt(5)
  s_cmp_ge_u32 s69, 1
  s_cbranch_scc1 L_ad122
  s_waitcnt vmcnt(4)
L_ad122:
  buffer_load_dwordx4 v7, s[36:39], s65 offen offset:3072 nt lds
  s_waitcnt vmcnt(6)
  s_cmp_ge_u32 s69, 2
  s_cbranch_scc1 L_ad123
  s_waitcnt vmcnt(5)
  s_cmp_ge_u32 s69, 1
  s_cbranch_scc1 L_ad123
  s_waitcnt vmcnt(4)
L_ad123:
  s_add_u32 m0, s64, 8192
  s_mov_b32 s65, 294912
  buffer_load_dwordx4 v6, s[36:39], s65 offen offset:0 nt lds
  ds_read_b64_tr_b16 v[178:179], v12 offset:28672
  ds_read_b64_tr_b16 v[182:183], v13 offset:28672
  ds_read_b64_tr_b16 v[186:187], v14 offset:28672
  ds_read_b64_tr_b16 v[190:191], v15 offset:28672
  ds_read_b64_tr_b16 v[194:195], v16 offset:28672
  ds_read_b64_tr_b16 v[198:199], v17 offset:28672
  ds_read_b64_tr_b16 v[202:203], v18 offset:28672
  ds_read_b64_tr_b16 v[206:207], v19 offset:28672
  s_waitcnt lgkmcnt(7)
  v_mfma_f32_16x16x32_bf16 v[208:211], v[244:247], v[176:179], v[208:211]
  s_waitcnt lgkmcnt(6)
  v_mfma_f32_16x16x32_bf16 v[212:215], v[244:247], v[180:183], v[212:215]
  s_waitcnt lgkmcnt(5)
  v_mfma_f32_16x16x32_bf16 v[216:219], v[244:247], v[184:187], v[216:219]
  s_waitcnt lgkmcnt(4)
  v_mfma_f32_16x16x32_bf16 v[220:223], v[244:247], v[188:191], v[220:223]
  s_waitcnt lgkmcnt(3)
  v_mfma_f32_16x16x32_bf16 v[224:227], v[244:247], v[192:195], v[224:227]
  s_waitcnt lgkmcnt(2)
  v_mfma_f32_16x16x32_bf16 v[228:231], v[244:247], v[196:199], v[228:231]
  s_waitcnt lgkmcnt(1)
  v_mfma_f32_16x16x32_bf16 v[232:235], v[244:247], v[200:203], v[232:235]
  s_waitcnt lgkmcnt(0)
  v_mfma_f32_16x16x32_bf16 v[236:239], v[244:247], v[204:207], v[236:239]
  s_waitcnt vmcnt(6)
  s_cmp_ge_u32 s69, 2
  s_cbranch_scc1 L_ad124
  s_waitcnt vmcnt(5)
  s_cmp_ge_u32 s69, 1
  s_cbranch_scc1 L_ad124
  s_waitcnt vmcnt(4)
L_ad124:
  buffer_load_dwordx4 v7, s[36:39], s65 offen offset:1024 nt lds
  s_waitcnt vmcnt(6)
  s_cmp_ge_u32 s69, 2
  s_cbranch_scc1 L_ad125
  s_waitcnt vmcnt(5)
  s_cmp_ge_u32 s69, 1
  s_cbranch_scc1 L_ad125
  s_waitcnt vmcnt(4)
L_ad125:
  buffer_load_dwordx4 v6, s[36:39], s65 offen offset:2048 nt lds
  s_waitcnt vmcnt(6)
  s_cmp_ge_u32 s69, 2
  s_cbranch_scc1 L_ad126
  s_waitcnt vmcnt(5)
  s_cmp_ge_u32 s69, 1
  s_cbranch_scc1 L_ad126
  s_waitcnt vmcnt(4)
L_ad126:
  buffer_load_dwordx4 v7, s[36:39], s65 offen offset:3072 nt lds
  v_readfirstlane_b32 s69, v253
  ds_read_b32 v253, v254
  s_cmp_lg_u32 s3, 0
  s_cbranch_scc1 L_ck127
  s_memrealtime s[84:85]
  s_waitcnt lgkmcnt(0)
  v_mov_b32 v26, 6
  v_mov_b32 v27, s84
  s_mov_b64 exec, 1
  ds_write_b64 v255, v[26:27]
  s_mov_b64 exec, -1
L_ck127:
  s_waitcnt vmcnt(6)
  s_cmp_ge_u32 s69, 2
  s_cbranch_scc1 L_ad128
  s_waitcnt vmcnt(5)
  s_cmp_ge_u32 s69, 1
  s_cbranch_scc1 L_ad128
  s_waitcnt vmcnt(4)
L_ad128:
  s_add_u32 m0, s64, 12288
  s_mov_b32 s65, 311296
  buffer_load_dwordx4 v6, s[36:39], s65 offen offset:0 nt lds
  ds_read_b64_tr_b16 v[144:145], v12 offset:0
  ds_read_b64_tr_b16 v[148:149], v13 offset:0
  ds_read_b64_tr_b16 v[152:153], v14 offset:0
  ds_read_b64_tr_b16 v[156:157], v15 offset:0
  ds_read_b64_tr_b16 v[160:161], v16 offset:0
  ds_read_b64_tr_b16 v[164:165], v17 offset:0
  ds_read_b64_tr_b16 v[168:169], v18 offset:0
  ds_read_b64_tr_b16 v[172:173], v19 offset:0
  s_waitcnt vmcnt(6)
  s_cmp_ge_u32 s69, 2
  s_cbranch_scc1 L_ad129
  s_waitcnt vmcnt(5)
  s_cmp_ge_u32 s69, 1
  s_cbranch_scc1 L_ad129
  s_waitcnt vmcnt(4)
L_ad129:
  buffer_load_dwordx4 v7, s[36:39], s65 offen offset:1024 nt lds
  s_waitcnt vmcnt(6)
  s_cmp_ge_u32 s69, 2
  s_cbranch_scc1 L_ad130
  s_waitcnt vmcnt(5)
  s_cmp_ge_u32 s69, 1
  s_cbranch_scc1 L_ad130
  s_waitcnt vmcnt(4)
L_ad130:
  buffer_load_dwordx4 v6, s[36:39], s65 offen offset:2048 nt lds
  s_waitcnt vmcnt(6)
  s_cmp_ge_u32 s69, 2
  s_cbranch_scc1 L_ad131
  s_waitcnt vmcnt(5)
  s_cmp_ge_u32 s69, 1
  s_cbranch_scc1 L_ad131
  s_waitcnt vmcnt(4)
L_ad131:
  buffer_load_dwordx4 v7, s[36:39], s65 offen offset:3072 nt lds
  s_waitcnt vmcnt(6)
  s_cmp_ge_u32 s69, 2
  s_cbranch_scc1 L_ad132
  s_waitcnt vmcnt(5)
  s_cmp_ge_u32 s69, 1
  s_cbranch_scc1 L_ad132
  s_waitcnt vmcnt(4)
L_ad132:
  s_add_u32 m0, s64, 16384
  s_mov_b32 s65, 327680
  buffer_load_dwordx4 v6, s[36:39], s65 offen offset:0 nt lds
  ds_read_b64_tr_b16 v[146:147], v12 offset:4096
  ds_read_b64_tr_b16 v[150:151], v13 offset:4096
  ds_read_b64_tr_b16 v[154:155], v14 offset:4096
  ds_read_b64_tr_b16 v[158:159], v15 offset:4096
  ds_read_b64_tr_b16 v[162:163], v16 offset:4096
  ds_read_b64_tr_b16 v[166:167], v17 offset:4096
  ds_read_b64_tr_b16 v[170:171], v18 offset:4096
  ds_read_b64_tr_b16 v[174:175], v19 offset:4096
  s_waitcnt lgkmcnt(7)
  v_mfma_f32_16x16x32_bf16 v[208:211], v[136:139], v[144:147], v[208:211]
  s_waitcnt lgkmcnt(6)
  v_mfma_f32_16x16x32_bf16 v[212:215], v[136:139], v[148:151], v[212:215]
  s_waitcnt lgkmcnt(5)
  v_mfma_f32_16x16x32_bf16 v[216:219], v[136:139], v[152:155], v[216:219]
  s_waitcnt lgkmcnt(4)
  v_mfma_f32_16x16x32_bf16 v[220:223], v[136:139], v[156:159], v[220:223]
  s_waitcnt lgkmcnt(3)
  v_mfma_f32_16x16x32_bf16 v[224:227], v[136:139], v[160:163], v[224:227]
  s_waitcnt lgkmcnt(2)
  v_mfma_f32_16x16x32_bf16 v[228:231], v[136:139], v[164:167], v[228:231]
  s_waitcnt lgkmcnt(1)
  v_mfma_f32_16x16x32_bf16 v[232:235], v[136:139], v[168:171], v[232:235]
  s_waitcnt lgkmcnt(0)
  v_mfma_f32_16x16x32_bf16 v[236:239], v[136:139], v[172:175], v[236:239]
  s_waitcnt vmcnt(6)
  s_cmp_ge_u32 s69, 2
  s_cbranch_scc1 L_ad133
  s_waitcnt vmcnt(5)
  s_cmp_ge_u32 s69, 1
  s_cbranch_scc1 L_ad133
  s_waitcnt vmcnt(4)
L_ad133:
  buffer_load_dwordx4 v7, s[36:39], s65 offen offset:1024 nt lds
  s_waitcnt vmcnt(6)
  s_cmp_ge_u32 s69, 2
  s_cbranch_scc1 L_ad134
  s_waitcnt vmcnt(5)
  s_cmp_ge_u32 s69, 1
  s_cbranch_scc1 L_ad134
  s_waitcnt vmcnt(4)
L_ad134:
  buffer_load_dwordx4 v6, s[36:39], s65 offen offset:2048 nt lds
  s_waitcnt vmcnt(6)
  s_cmp_ge_u32 s69, 2
  s_cbranch_scc1 L_ad135
  s_waitcnt vmcnt(5)
  s_cmp_ge_u32 s69, 1
  s_cbranch_scc1 L_ad135
  s_waitcnt vmcnt(4)
L_ad135:
  buffer_load_dwordx4 v7, s[36:39], s65 offen offset:3072 nt lds
  v_readfirstlane_b32 s69, v253
  ds_read_b32 v253, v254
  s_waitcnt vmcnt(6)
  s_cmp_ge_u32 s69, 2
  s_cbranch_scc1 L_ad136
  s_waitcnt vmcnt(5)
  s_cmp_ge_u32 s69, 1
  s_cbranch_scc1 L_ad136
  s_waitcnt vmcnt(4)
L_ad136:
  s_add_u32 m0, s64, 20480
  s_mov_b32 s65, 344064
  buffer_load_dwordx4 v6, s[36:39], s65 offen offset:0 nt lds
  ds_read_b64_tr_b16 v[176:177], v12 offset:8192
  ds_read_b64_tr_b16 v[180:181], v13 offset:8192
  ds_read_b64_tr_b16 v[184:185], v14 offset:8192
  ds_read_b64_tr_b16 v[188:189], v15 offset:8192
  ds_read_b64_tr_b16 v[192:193], v16 offset:8192
  ds_read_b64_tr_b16 v[196:197], v17 offset:8192
  ds_read_b64_tr_b16 v[200:201], v18 offset:8192
  ds_read_b64_tr_b16 v[204:205], v19 offset:8192
  v_mov_b32_dpp v244, v136 row_shl:4 row_mask:0xf bank_mask:0xf bound_ctrl:0
  v_mov_b32_dpp v245, v137 row_shl:4 row_mask:0xf bank_mask:0xf bound_ctrl:0
  v_mov_b32_dpp v246, v138 row_shl:4 row_mask:0xf bank_mask:0xf bound_ctrl:0
  v_mov_b32_dpp v247, v139 row_shl:4 row_mask:0xf bank_mask:0xf bound_ctrl:0
  s_waitcnt vmcnt(6)
  s_cmp_ge_u32 s69, 2
  s_cbranch_scc1 L_ad137
  s_waitcnt vmcnt(5)
  s_cmp_ge_u32 s69, 1
  s_cbranch_scc1 L_ad137
  s_waitcnt vmcnt(4)
L_ad137:
  buffer_load_dwordx4 v7, s[36:39], s65 offen offset:1024 nt lds
  s_waitcnt vmcnt(6)
  s_cmp_ge_u32 s69, 2
  s_cbranch_scc1 L_ad138
  s_waitcnt vmcnt(5)
  s_cmp_ge_u32 s69, 1
  s_cbranch_scc1 L_ad138
  s_waitcnt vmcnt(4)
L_ad138:
  buffer_load_dwordx4 v6, s[36:39], s65 offen offset:2048 nt lds
  s_waitcnt vmcnt(6)
  s_cmp_ge_u32 s69, 2
  s_cbranch_scc1 L_ad139
  s_waitcnt vmcnt(5)
  s_cmp_ge_u32 s69, 1
  s_cbranch_scc1 L_ad139
  s_waitcnt vmcnt(4)
L_ad139:
  buffer_load_dwordx4 v7, s[36:39], s65 offen offset:3072 nt lds
  s_waitcnt vmcnt(6)
  s_cmp_ge_u32 s69, 2
  s_cbranch_scc1 L_ad140
  s_waitcnt vmcnt(5)
  s_cmp_ge_u32 s69, 1
  s_cbranch_scc1 L_ad140
  s_waitcnt vmcnt(4)
L_ad140:
  s_add_u32 m0, s64, 24576
  s_mov_b32 s65, 360448
  buffer_load_dwordx4 v6, s[36:39], s65 offen offset:0 nt lds
  ds_read_b64_tr_b16 v[178:179], v12 offset:12288
  ds_read_b64_tr_b16 v[182:183], v13 offset:12288
  ds_read_b64_tr_b16 v[186:187], v14 offset:12288
  ds_read_b64_tr_b16 v[190:191], v15 offset:12288
  ds_read_b64_tr_b16 v[194:195], v16 offset:12288
  ds_read_b64_tr_b16 v[198:199], v17 offset:12288
  ds_read_b64_tr_b16 v[202:203], v18 offset:12288
  ds_read_b64_tr_b16 v[206:207], v19 offset:12288
  s_waitcnt lgkmcnt(7)
  v_mfma_f32_16x16x32_bf16 v[208:211], v[244:247], v[176:179], v[208:211]
  s_waitcnt lgkmcnt(6)
  v_mfma_f32_16x16x32_bf16 v[212:215], v[244:247], v[180:183], v[212:215]
  s_waitcnt lgkmcnt(5)
  v_mfma_f32_16x16x32_bf16 v[216:219], v[244:247], v[184:187], v[216:219]
  s_waitcnt lgkmcnt(4)
  v_mfma_f32_16x16x32_bf16 v[220:223], v[244:247], v[188:191], v[220:223]
  s_waitcnt lgkmcnt(3)
  v_mfma_f32_16x16x32_bf16 v[224:227], v[244:247], v[192:195], v[224:227]
  s_waitcnt lgkmcnt(2)
  v_mfma_f32_16x16x32_bf16 v[228:231], v[244:247], v[196:199], v[228:231]
  s_waitcnt lgkmcnt(1)
  v_mfma_f32_16x16x32_bf16 v[232:235], v[244:247], v[200:203], v[232:235]
  s_waitcnt lgkmcnt(0)
  v_mfma_f32_16x16x32_bf16 v[236:239], v[244:247], v[204:207], v[236:239]
  s_waitcnt vmcnt(6)
  s_cmp_ge_u32 s69, 2
  s_cbranch_scc1 L_ad141
  s_waitcnt vmcnt(5)
  s_cmp_ge_u32 s69, 1
  s_cbranch_scc1 L_ad141
  s_waitcnt vmcnt(4)
L_ad141:
  buffer_load_dwordx4 v7, s[36:39], s65 offen offset:1024 nt lds
  s_waitcnt vmcnt(6)
  s_cmp_ge_u32 s69, 2
  s_cbranch_scc1 L_ad142
  s_waitcnt vmcnt(5)
  s_cmp_ge_u32 s69, 1
  s_cbranch_scc1 L_ad142
  s_waitcnt vmcnt(4)
L_ad142:
  buffer_load_dwordx4 v6, s[36:39], s65 offen offset:2048 nt lds
  s_waitcnt vmcnt(6)
  s_cmp_ge_u32 s69, 2
  s_cbranch_scc1 L_ad143
  s_waitcnt vmcnt(5)
  s_cmp_ge_u32 s69, 1
  s_cbranch_scc1 L_ad143
  s_waitcnt vmcnt(4)
L_ad143:
  buffer_load_dwordx4 v7, s[36:39], s65 offen offset:3072 nt lds
  v_readfirstlane_b32 s69, v253
  ds_read_b32 v253, v254
  s_waitcnt vmcnt(6)
  s_cmp_ge_u32 s69, 2
  s_cbranch_scc1 L_ad144
  s_waitcnt vmcnt(5)
  s_cmp_ge_u32 s69, 1
  s_cbranch_scc1 L_ad144
  s_waitcnt vmcnt(4)
L_ad144:
  s_add_u32 m0, s64, 28672
  s_mov_b32 s65, 376832
  buffer_load_dwordx4 v6, s[36:39], s65 offen offset:0 nt lds
  ds_read_b64_tr_b16 v[144:145], v12 offset:16384
  ds_read_b64_tr_b16 v[148:149], v13 offset:16384
  ds_read_b64_tr_b16 v[152:153], v14 offset:16384
  ds_read_b64_tr_b16 v[156:157], v15 offset:16384
  ds_read_b64_tr_b16 v[160:161], v16 offset:16384
  ds_read_b64_tr_b16 v[164:165], v17 offset:16384
  ds_read_b64_tr_b16 v[168:169], v18 offset:16384
  ds_read_b64_tr_b16 v[172:173], v19 offset:16384
  v_mov_b32_dpp v240, v136 row_shl:8 row_mask:0xf bank_mask:0xf bound_ctrl:0
  v_mov_b32_dpp v241, v137 row_shl:8 row_mask:0xf bank_mask:0xf bound_ctrl:0
  v_mov_b32_dpp v242, v138 row_shl:8 row_mask:0xf bank_mask:0xf bound_ctrl:0
  v_mov_b32_dpp v243, v139 row_shl:8 row_mask:0xf bank_mask:0xf bound_ctrl:0
  s_waitcnt vmcnt(6)
  s_cmp_ge_u32 s69, 2
  s_cbranch_scc1 L_ad145
  s_waitcnt vmcnt(5)
  s_cmp_ge_u32 s69, 1
  s_cbranch_scc1 L_ad145
  s_waitcnt vmcnt(4)
L_ad145:
  buffer_load_dwordx4 v7, s[36:39], s65 offen offset:1024 nt lds
  s_waitcnt vmcnt(6)
  s_cmp_ge_u32 s69, 2
  s_cbranch_scc1 L_ad146
  s_waitcnt vmcnt(5)
  s_cmp_ge_u32 s69, 1
  s_cbranch_scc1 L_ad146
  s_waitcnt vmcnt(4)
L_ad146:
  buffer_load_dwordx4 v6, s[36:39], s65 offen offset:2048 nt lds
  s_waitcnt vmcnt(6)
  s_cmp_ge_u32 s69, 2
  s_cbranch_scc1 L_ad147
  s_waitcnt vmcnt(5)
  s_cmp_ge_u32 s69, 1
  s_cbranch_scc1 L_ad147
  s_waitcnt vmcnt(4)
L_ad147:
  buffer_load_dwordx4 v7, s[36:39], s65 offen offset:3072 nt lds
  s_waitcnt vmcnt(6)
  s_cmp_ge_u32 s69, 2
  s_cbranch_scc1 L_ad148
  s_waitcnt vmcnt(5)
  s_cmp_ge_u32 s69, 1
  s_cbranch_scc1 L_ad148
  s_waitcnt vmcnt(4)
L_ad148:
  s_add_u32 m0, s64, 0
  s_mov_b32 s65, 393216
  buffer_load_dwordx4 v6, s[36:39], s65 offen offset:0 nt lds
  ds_read_b64_tr_b16 v[146:147], v12 offset:20480
  ds_read_b64_tr_b16 v[150:151], v13 offset:20480
  ds_read_b64_tr_b16 v[154:155], v14 offset:20480
  ds_read_b64_tr_b16 v[158:159], v15 offset:20480
  ds_read_b64_tr_b16 v[162:163], v16 offset:20480
  ds_read_b64_tr_b16 v[166:167], v17 offset:20480
  ds_read_b64_tr_b16 v[170:171], v18 offset:20480
  ds_read_b64_tr_b16 v[174:175], v19 offset:20480
  s_waitcnt lgkmcnt(7)
  v_mfma_f32_16x16x32_bf16 v[208:211], v[240:243], v[144:147], v[208:211]
  s_waitcnt lgkmcnt(6)
  v_mfma_f32_16x16x32_bf16 v[212:215], v[240:243], v[148:151], v[212:215]
  s_waitcnt lgkmcnt(5)
  v_mfma_f32_16x16x32_bf16 v[216:219], v[240:243], v[152:155], v[216:219]
  s_waitcnt lgkmcnt(4)
  v_mfma_f32_16x16x32_bf16 v[220:223], v[240:243], v[156:159], v[220:223]
  s_waitcnt lgkmcnt(3)
  v_mfma_f32_16x16x32_bf16 v[224:227], v[240:243], v[160:163], v[224:227]
  s_waitcnt lgkmcnt(2)
  v_mfma_f32_16x16x32_bf16 v[228:231], v[240:243], v[164:167], v[228:231]
  s_waitcnt lgkmcnt(1)
  v_mfma_f32_16x16x32_bf16 v[232:235], v[240:243], v[168:171], v[232:235]
  s_waitcnt lgkmcnt(0)
  v_mfma_f32_16x16x32_bf16 v[236:239], v[240:243], v[172:175], v[236:239]
  s_waitcnt vmcnt(6)
  s_cmp_ge_u32 s69, 2
  s_cbranch_scc1 L_ad149
  s_waitcnt vmcnt(5)
  s_cmp_ge_u32 s69, 1
  s_cbranch_scc1 L_ad149
  s_waitcnt vmcnt(4)
L_ad149:
  buffer_load_dwordx4 v7, s[36:39], s65 offen offset:1024 nt lds
  s_waitcnt vmcnt(6)
  s_cmp_ge_u32 s69, 2
  s_cbranch_scc1 L_ad150
  s_waitcnt vmcnt(5)
  s_cmp_ge_u32 s69, 1
  s_cbranch_scc1 L_ad150
  s_waitcnt vmcnt(4)
L_ad150:
  buffer_load_dwordx4 v6, s[36:39], s65 offen offset:2048 nt lds
  s_waitcnt vmcnt(6)
  s_cmp_ge_u32 s69, 2
  s_cbranch_scc1 L_ad151
  s_waitcnt vmcnt(5)
  s_cmp_ge_u32 s69, 1
  s_cbranch_scc1 L_ad151
  s_waitcnt vmcnt(4)
L_ad151:
  buffer_load_dwordx4 v7, s[36:39], s65 offen offset:3072 nt lds
  v_readfirstlane_b32 s69, v253
  ds_read_b32 v253, v254
  s_cmp_lg_u32 s3, 0
  s_cbranch_scc1 L_ck152
  s_memrealtime s[84:85]
  s_waitcnt lgkmcnt(0)
  v_mov_b32 v26, 7
  v_mov_b32 v27, s84
  s_mov_b64 exec, 1
  ds_write_b64 v255, v[26:27]
  s_mov_b64 exec, -1
L_ck152:
  s_waitcnt vmcnt(6)
  s_cmp_ge_u32 s69, 2
  s_cbranch_scc1 L_ad153
  s_waitcnt vmcnt(5)
  s_cmp_ge_u32 s69, 1
  s_cbranch_scc1 L_ad153
  s_waitcnt vmcnt(4)
L_ad153:
  s_add_u32 m0, s64, 4096
  s_mov_b32 s65, 409600
  buffer_load_dwordx4 v6, s[36:39], s65 offen offset:0 nt lds
  ds_read_b64_tr_b16 v[176:177], v12 offset:24576
  ds_read_b64_tr_b16 v[180:181], v13 offset:24576
  ds_read_b64_tr_b16 v[184:185], v14 offset:24576
  ds_read_b64_tr_b16 v[188:189], v15 offset:24576
  ds_read_b64_tr_b16 v[192:193], v16 offset:24576
  ds_read_b64_tr_b16 v[196:197], v17 offset:24576
  ds_read_b64_tr_b16 v[200:201], v18 offset:24576
  ds_read_b64_tr_b16 v[204:205], v19 offset:24576
  v_mov_b32_dpp v244, v136 row_shl:12 row_mask:0xf bank_mask:0xf bound_ctrl:0
  v_mov_b32_dpp v245, v137 row_shl:12 row_mask:0xf bank_mask:0xf bound_ctrl:0
  v_mov_b32_dpp v246, v138 row_shl:12 row_mask:0xf bank_mask:0xf bound_ctrl:0
  v_mov_b32_dpp v247, v139 row_shl:12 row_mask:0xf bank_mask:0xf bound_ctrl:0
  s_waitcnt vmcnt(6)
  s_cmp_ge_u32 s69, 2
  s_cbranch_scc1 L_ad154
  s_waitcnt vmcnt(5)
  s_cmp_ge_u32 s69, 1
  s_cbranch_scc1 L_ad154
  s_waitcnt vmcnt(4)
L_ad154:
  buffer_load_dwordx4 v7, s[36:39], s65 offen offset:1024 nt lds
  s_waitcnt vmcnt(6)
  s_cmp_ge_u32 s69, 2
  s_cbranch_scc1 L_ad155
  s_waitcnt vmcnt(5)
  s_cmp_ge_u32 s69, 1
  s_cbranch_scc1 L_ad155
  s_waitcnt vmcnt(4)
L_ad155:
  buffer_load_dwordx4 v6, s[36:39], s65 offen offset:2048 nt lds
  s_waitcnt vmcnt(6)
  s_cmp_ge_u32 s69, 2
  s_cbranch_scc1 L_ad156
  s_waitcnt vmcnt(5)
  s_cmp_ge_u32 s69, 1
  s_cbranch_scc1 L_ad156
  s_waitcnt vmcnt(4)
L_ad156:
  buffer_load_dwordx4 v7, s[36:39], s65 offen offset:3072 nt lds
  s_waitcnt vmcnt(6)
  s_cmp_ge_u32 s69, 2
  s_cbranch_scc1 L_ad157
  s_waitcnt vmcnt(5)
  s_cmp_ge_u32 s69, 1
  s_cbranch_scc1 L_ad157
  s_waitcnt vmcnt(4)
L_ad157:
  s_add_u32 m0, s64, 8192
  s_mov_b32 s65, 425984
  buffer_load_dwordx4 v6, s[36:39], s65 offen offset:0 nt lds
  ds_read_b64_tr_b16 v[178:179], v12 offset:28672
  ds_read_b64_tr_b16 v[182:183], v13 offset:28672
  ds_read_b64_tr_b16 v[186:187], v14 offset:28672
  ds_read_b64_tr_b16 v[190:191], v15 offset:28672
  ds_read_b64_tr_b16 v[194:195], v16 offset:28672
  ds_read_b64_tr_b16 v[198:199], v17 offset:28672
  ds_read_b64_tr_b16 v[202:203], v18 offset:28672
  ds_read_b64_tr_b16 v[206:207], v19 offset:28672
  s_waitcnt lgkmcnt(7)
  v_mfma_f32_16x16x32_bf16 v[208:211], v[244:247], v[176:179], v[208:211]
  s_waitcnt lgkmcnt(6)
  v_mfma_f32_16x16x32_bf16 v[212:215], v[244:247], v[180:183], v[212:215]
  s_waitcnt lgkmcnt(5)
  v_mfma_f32_16x16x32_bf16 v[216:219], v[244:247], v[184:187], v[216:219]
  s_waitcnt lgkmcnt(4)
  v_mfma_f32_16x16x32_bf16 v[220:223], v[244:247], v[188:191], v[220:223]
  s_waitcnt lgkmcnt(3)
  v_mfma_f32_16x16x32_bf16 v[224:227], v[244:247], v[192:195], v[224:227]
  s_waitcnt lgkmcnt(2)
  v_mfma_f32_16x16x32_bf16 v[228:231], v[244:247], v[196:199], v[228:231]
  s_waitcnt lgkmcnt(1)
  v_mfma_f32_16x16x32_bf16 v[232:235], v[244:247], v[200:203], v[232:235]
  s_waitcnt lgkmcnt(0)
  v_mfma_f32_16x16x32_bf16 v[236:239], v[244:247], v[204:207], v[236:239]
  s_waitcnt vmcnt(6)
  s_cmp_ge_u32 s69, 2
  s_cbranch_scc1 L_ad158
  s_waitcnt vmcnt(5)
  s_cmp_ge_u32 s69, 1
  s_cbranch_scc1 L_ad158
  s_waitcnt vmcnt(4)
L_ad158:
  buffer_load_dwordx4 v7, s[36:39], s65 offen offset:1024 nt lds
  s_waitcnt vmcnt(6)
  s_cmp_ge_u32 s69, 2
  s_cbranch_scc1 L_ad159
  s_waitcnt vmcnt(5)
  s_cmp_ge_u32 s69, 1
  s_cbranch_scc1 L_ad159
  s_waitcnt vmcnt(4)
L_ad159:
  buffer_load_dwordx4 v6, s[36:39], s65 offen offset:2048 nt lds
  s_waitcnt vmcnt(6)
  s_cmp_ge_u32 s69, 2
  s_cbranch_scc1 L_ad160
  s_waitcnt vmcnt(5)
  s_cmp_ge_u32 s69, 1
  s_cbranch_scc1 L_ad160
  s_waitcnt vmcnt(4)
L_ad160:
  buffer_load_dwordx4 v7, s[36:39], s65 offen offset:3072 nt lds
  v_readfirstlane_b32 s69, v253
  ds_read_b32 v253, v254
  s_waitcnt vmcnt(6)
  s_cmp_ge_u32 s69, 2
  s_cbranch_scc1 L_ad161
  s_waitcnt vmcnt(5)
  s_cmp_ge_u32 s69, 1
  s_cbranch_scc1 L_ad161
  s_waitcnt vmcnt(4)
L_ad161:
  s_add_u32 m0, s64, 12288
  s_mov_b32 s65, 442368
  buffer_load_dwordx4 v6, s[36:39], s65 offen offset:0 nt lds
  ds_read_b64_tr_b16 v[144:145], v12 offset:0
  ds_read_b64_tr_b16 v[148:149], v13 offset:0
  ds_read_b64_tr_b16 v[152:153], v14 offset:0
  ds_read_b64_tr_b16 v[156:157], v15 offset:0
  ds_read_b64_tr_b16 v[160:161], v16 offset:0
  ds_read_b64_tr_b16 v[164:165], v17 offset:0
  ds_read_b64_tr_b16 v[168:169], v18 offset:0
  ds_read_b64_tr_b16 v[172:173], v19 offset:0
  s_waitcnt vmcnt(6)
  s_cmp_ge_u32 s69, 2
  s_cbranch_scc1 L_ad162
  s_waitcnt vmcnt(5)
  s_cmp_ge_u32 s69, 1
  s_cbranch_scc1 L_ad162
  s_waitcnt vmcnt(4)
L_ad162:
  buffer_load_dwordx4 v7, s[36:39], s65 offen offset:1024 nt lds
  s_waitcnt vmcnt(6)
  s_cmp_ge_u32 s69, 2
  s_cbranch_scc1 L_ad163
  s_waitcnt vmcnt(5)
  s_cmp_ge_u32 s69, 1
  s_cbranch_scc1 L_ad163
  s_waitcnt vmcnt(4)
L_ad163:
  buffer_load_dwordx4 v6, s[36:39], s65 offen offset:2048 nt lds
  s_waitcnt vmcnt(6)
  s_cmp_ge_u32 s69, 2
  s_cbranch_scc1 L_ad164
  s_waitcnt vmcnt(5)
  s_cmp_ge_u32 s69, 1
  s_cbranch_scc1 L_ad164
  s_waitcnt vmcnt(4)
L_ad164:
  buffer_load_dwordx4 v7, s[36:39], s65 offen offset:3072 nt lds
  s_waitcnt vmcnt(6)
  s_cmp_ge_u32 s69, 2
  s_cbranch_scc1 L_ad165
  s_waitcnt vmcnt(5)
  s_cmp_ge_u32 s69, 1
  s_cbranch_scc1 L_ad165
  s_waitcnt vmcnt(4)
L_ad165:
  s_add_u32 m0, s64, 16384
  s_mov_b32 s65, 458752
  buffer_load_dwordx4 v6, s[36:39], s65 offen offset:0 nt lds
  ds_read_b64_tr_b16 v[146:147], v12 offset:4096
  ds_read_b64_tr_b16 v[150:151], v13 offset:4096
  ds_read_b64_tr_b16 v[154:155], v14 offset:4096
  ds_read_b64_tr_b16 v[158:159], v15 offset:4096
  ds_read_b64_tr_b16 v[162:163], v16 offset:4096
  ds_read_b64_tr_b16 v[166:167], v17 offset:4096
  ds_read_b64_tr_b16 v[170:171], v18 offset:4096
  ds_read_b64_tr_b16 v[174:175], v19 offset:4096
  s_waitcnt lgkmcnt(7)
  v_mfma_f32_16x16x32_bf16 v[208:211], v[140:143], v[144:147], v[208:211]
  s_waitcnt lgkmcnt(6)
  v_mfma_f32_16x16x32_bf16 v[212:215], v[140:143], v[148:151], v[212:215]
  s_waitcnt lgkmcnt(5)
  v_mfma_f32_16x16x32_bf16 v[216:219], v[140:143], v[152:155], v[216:219]
  s_waitcnt lgkmcnt(4)
  v_mfma_f32_16x16x32_bf16 v[220:223], v[140:143], v[156:159], v[220:223]
  s_waitcnt lgkmcnt(3)
  v_mfma_f32_16x16x32_bf16 v[224:227], v[140:143], v[160:163], v[224:227]
  s_waitcnt lgkmcnt(2)
  v_mfma_f32_16x16x32_bf16 v[228:231], v[140:143], v[164:167], v[228:231]
  s_waitcnt lgkmcnt(1)
  v_mfma_f32_16x16x32_bf16 v[232:235], v[140:143], v[168:171], v[232:235]
  s_waitcnt lgkmcnt(0)
  v_mfma_f32_16x16x32_bf16 v[236:239], v[140:143], v[172:175], v[236:239]
  s_waitcnt vmcnt(6)
  s_cmp_ge_u32 s69, 2
  s_cbranch_scc1 L_ad166
  s_waitcnt vmcnt(5)
  s_cmp_ge_u32 s69, 1
  s_cbranch_scc1 L_ad166
  s_waitcnt vmcnt(4)
L_ad166:
  buffer_load_dwordx4 v7, s[36:39], s65 offen offset:1024 nt lds
  s_waitcnt vmcnt(6)
  s_cmp_ge_u32 s69, 2
  s_cbranch_scc1 L_ad167
  s_waitcnt vmcnt(5)
  s_cmp_ge_u32 s69, 1
  s_cbranch_scc1 L_ad167
  s_waitcnt vmcnt(4)
L_ad167:
  buffer_load_dwordx4 v6, s[36:39], s65 offen offset:2048 nt lds
  s_waitcnt vmcnt(6)
  s_cmp_ge_u32 s69, 2
  s_cbranch_scc1 L_ad168
  s_waitcnt vmcnt(5)
  s_cmp_ge_u32 s69, 1
  s_cbranch_scc1 L_ad168
  s_waitcnt vmcnt(4)
L_ad168:
  buffer_load_dwordx4 v7, s[36:39], s65 offen offset:3072 nt lds
  v_readfirstlane_b32 s69, v253
  ds_read_b32 v253, v254
  s_waitcnt vmcnt(6)
  s_cmp_ge_u32 s69, 2
  s_cbranch_scc1 L_ad169
  s_waitcnt vmcnt(5)
  s_cmp_ge_u32 s69, 1
  s_cbranch_scc1 L_ad169
  s_waitcnt vmcnt(4)
L_ad169:
  s_add_u32 m0, s64, 20480
  s_mov_b32 s65, 475136
  buffer_load_dwordx4 v6, s[36:39], s65 offen offset:0 nt lds
  ds_read_b64_tr_b16 v[176:177], v12 offset:8192
  ds_read_b64_tr_b16 v[180:181], v13 offset:8192
  ds_read_b64_tr_b16 v[184:185], v14 offset:8192
  ds_read_b64_tr_b16 v[188:189], v15 offset:8192
  ds_read_b64_tr_b16 v[192:193], v16 offset:8192
  ds_read_b64_tr_b16 v[196:197], v17 offset:8192
  ds_read_b64_tr_b16 v[200:201], v18 offset:8192
  ds_read_b64_tr_b16 v[204:205], v19 offset:8192
  v_mov_b32_dpp v244, v140 row_shl:4 row_mask:0xf bank_mask:0xf bound_ctrl:0
  v_mov_b32_dpp v245, v141 row_shl:4 row_mask:0xf bank_mask:0xf bound_ctrl:0
  v_mov_b32_dpp v246, v142 row_shl:4 row_mask:0xf bank_mask:0xf bound_ctrl:0
  v_mov_b32_dpp v247, v143 row_shl:4 row_mask:0xf bank_mask:0xf bound_ctrl:0
  s_waitcnt vmcnt(6)
  s_cmp_ge_u32 s69, 2
  s_cbranch_scc1 L_ad170
  s_waitcnt vmcnt(5)
  s_cmp_ge_u32 s69, 1
  s_cbranch_scc1 L_ad170
  s_waitcnt vmcnt(4)
L_ad170:
  buffer_load_dwordx4 v7, s[36:39], s65 offen offset:1024 nt lds
  s_waitcnt vmcnt(6)
  s_cmp_ge_u32 s69, 2
  s_cbranch_scc1 L_ad171
  s_waitcnt vmcnt(5)
  s_cmp_ge_u32 s69, 1
  s_cbranch_scc1 L_ad171
  s_waitcnt vmcnt(4)
L_ad171:
  buffer_load_dwordx4 v6, s[36:39], s65 offen offset:2048 nt lds
  s_waitcnt vmcnt(6)
  s_cmp_ge_u32 s69, 2
  s_cbranch_scc1 L_ad172
  s_waitcnt vmcnt(5)
  s_cmp_ge_u32 s69, 1
  s_cbranch_scc1 L_ad172
  s_waitcnt vmcnt(4)
L_ad172:
  buffer_load_dwordx4 v7, s[36:39], s65 offen offset:3072 nt lds
  s_waitcnt vmcnt(6)
  s_cmp_ge_u32 s69, 2
  s_cbranch_scc1 L_ad173
  s_waitcnt vmcnt(5)
  s_cmp_ge_u32 s69, 1
  s_cbranch_scc1 L_ad173
  s_waitcnt vmcnt(4)
L_ad173:
  s_add_u32 m0, s64, 24576
  s_mov_b32 s65, 491520
  buffer_load_dwordx4 v6, s[36:39], s65 offen offset:0 nt lds
  v_mov_b32 v25, 151044
  s_mov_b32 s70, 240000
L_ffwait:
  ds_read_b32 v26, v25
  s_waitcnt lgkmcnt(0)
  v_readfirstlane_b32 s79, v26
  s_nop 0
  s_cmp_lg_u32 s79, 0
  s_cbranch_scc1 L_ffok
  s_sub_u32 s70, s70, 1
  s_cmp_lg_u32 s70, 0
  s_cbranch_scc0 L_ffok
  s_sleep 2
  s_branch L_ffwait
L_ffok:
  v_mov_b32 v25, 150784
  ds_read_b128 v[96:99], v25 offset:0
  ds_read_b128 v[100:103], v25 offset:16
  ds_read_b128 v[104:107], v25 offset:32
  ds_read_b128 v[108:111], v25 offset:48
  s_waitcnt lgkmcnt(0)
  v_lshlrev_b32 v25, 4, v1
  s_lshl_b32 s79, s3, 11
  s_add_u32 s79, s79, 131072
  v_add_u32 v25, s79, v25
  v_lshlrev_b32 v26, 4, v0
  v_add_u32 v26, 131072, v26
  s_lshl_b32 s79, s67, 15
  s_lshl_b32 s82, s68, 7
  s_add_u32 s82, s79, s82
  s_add_u32 s82, s82, 262144
  v_lshrrev_b32 v27, 3, v0
  v_lshlrev_b32 v27, 11, v27
  v_and_b32 v28, 7, v0
  v_lshl_add_u32 v27, v28, 4, v27
  v_add_u32 v27, s82, v27
  s_lshl_b32 s82, s68, 11
  s_add_u32 s79, s79, s82
  s_add_u32 s79, s79, 262144
  v_lshlrev_b32 v21, 4, v1
  v_add_u32 v21, s79, v21
  s_lshl_b32 s79, s2, 11
  s_lshl_b32 s82, s3, 9
  s_add_u32 s79, s79, s82
  s_add_u32 s79, s79, 786432
  v_and_b32 v28, 31, v1
  v_lshlrev_b32 v28, 4, v28
  v_lshrrev_b32 v29, 5, v1
  v_lshl_add_u32 v28, v29, 3, v28
  v_add_u32 v28, s79, v28
  s_lshr_b32 s79, s2, 7
  s_lshl_b32 s79, s79, 18
  s_and_b32 s82, s2, 127
  s_lshl_b32 s82, s82, 4
  s_add_u32 s79, s79, s82
  s_add_u32 s79, s79, 786432
  v_lshlrev_b32 v29, 11, v1
  v_add_u32 v29, s79, v29
  s_mov_b32 s80, 0x05040100
  s_mov_b32 s81, 0x07060302
  s_mov_b32 s83, 131072
  s_mov_b32 s48, s24
  s_and_b32 s49, s25, 0xffff
  s_mov_b32 s50, 0x800
  s_mov_b32 s51, 0x20000
  ds_read_b64_tr_b16 v[178:179], v12 offset:12288
  ds_read_b64_tr_b16 v[182:183], v13 offset:12288
  ds_read_b64_tr_b16 v[186:187], v14 offset:12288
  ds_read_b64_tr_b16 v[190:191], v15 offset:12288
  ds_read_b64_tr_b16 v[194:195], v16 offset:12288
  ds_read_b64_tr_b16 v[198:199], v17 offset:12288
  ds_read_b64_tr_b16 v[202:203], v18 offset:12288
  ds_read_b64_tr_b16 v[206:207], v19 offset:12288
  s_waitcnt lgkmcnt(7)
  v_mfma_f32_16x16x32_bf16 v[208:211], v[244:247], v[176:179], v[208:211]
  s_waitcnt lgkmcnt(6)
  v_mfma_f32_16x16x32_bf16 v[212:215], v[244:247], v[180:183], v[212:215]
  s_waitcnt lgkmcnt(5)
  v_mfma_f32_16x16x32_bf16 v[216:219], v[244:247], v[184:187], v[216:219]
  s_waitcnt lgkmcnt(4)
  v_mfma_f32_16x16x32_bf16 v[220:223], v[244:247], v[188:191], v[220:223]
  s_waitcnt lgkmcnt(3)
  v_mfma_f32_16x16x32_bf16 v[224:227], v[244:247], v[192:195], v[224:227]
  s_waitcnt lgkmcnt(2)
  v_mfma_f32_16x16x32_bf16 v[228:231], v[244:247], v[196:199], v[228:231]
  s_waitcnt lgkmcnt(1)
  v_mfma_f32_16x16x32_bf16 v[232:235], v[244:247], v[200:203], v[232:235]
  s_waitcnt lgkmcnt(0)
  v_mfma_f32_16x16x32_bf16 v[236:239], v[244:247], v[204:207], v[236:239]
  s_waitcnt vmcnt(6)
  s_cmp_ge_u32 s69, 2
  s_cbranch_scc1 L_ad174
  s_waitcnt vmcnt(5)
  s_cmp_ge_u32 s69, 1
  s_cbranch_scc1 L_ad174
  s_waitcnt vmcnt(4)
L_ad174:
  buffer_load_dwordx4 v7, s[36:39], s65 offen offset:1024 nt lds
  s_waitcnt vmcnt(6)
  s_cmp_ge_u32 s69, 2
  s_cbranch_scc1 L_ad175
  s_waitcnt vmcnt(5)
  s_cmp_ge_u32 s69, 1
  s_cbranch_scc1 L_ad175
  s_waitcnt vmcnt(4)
L_ad175:
  buffer_load_dwordx4 v6, s[36:39], s65 offen offset:2048 nt lds
  s_waitcnt vmcnt(6)
  s_cmp_ge_u32 s69, 2
  s_cbranch_scc1 L_ad176
  s_waitcnt vmcnt(5)
  s_cmp_ge_u32 s69, 1
  s_cbranch_scc1 L_ad176
  s_waitcnt vmcnt(4)
L_ad176:
  buffer_load_dwordx4 v7, s[36:39], s65 offen offset:3072 nt lds
  v_readfirstlane_b32 s69, v253
  ds_read_b32 v253, v254
  s_waitcnt vmcnt(6)
  s_cmp_ge_u32 s69, 2
  s_cbranch_scc1 L_ad177
  s_waitcnt vmcnt(5)
  s_cmp_ge_u32 s69, 1
  s_cbranch_scc1 L_ad177
  s_waitcnt vmcnt(4)
L_ad177:
  s_add_u32 m0, s64, 28672
  s_mov_b32 s65, 507904
  buffer_load_dwordx4 v6, s[36:39], s65 offen offset:0 nt lds
  ds_read_b64_tr_b16 v[144:145], v12 offset:16384
  ds_read_b64_tr_b16 v[148:149], v13 offset:16384
  ds_read_b64_tr_b16 v[152:153], v14 offset:16384
  ds_read_b64_tr_b16 v[156:157], v15 offset:16384
  ds_read_b64_tr_b16 v[160:161], v16 offset:16384
  ds_read_b64_tr_b16 v[164:165], v17 offset:16384
  ds_read_b64_tr_b16 v[168:169], v18 offset:16384
  ds_read_b64_tr_b16 v[172:173], v19 offset:16384
  v_mov_b32_dpp v240, v140 row_shl:8 row_mask:0xf bank_mask:0xf bound_ctrl:0
  v_mov_b32_dpp v241, v141 row_shl:8 row_mask:0xf bank_mask:0xf bound_ctrl:0
  v_mov_b32_dpp v242, v142 row_shl:8 row_mask:0xf bank_mask:0xf bound_ctrl:0
  v_mov_b32_dpp v243, v143 row_shl:8 row_mask:0xf bank_mask:0xf bound_ctrl:0
  s_waitcnt vmcnt(6)
  s_cmp_ge_u32 s69, 2
  s_cbranch_scc1 L_ad178
  s_waitcnt vmcnt(5)
  s_cmp_ge_u32 s69, 1
  s_cbranch_scc1 L_ad178
  s_waitcnt vmcnt(4)
L_ad178:
  buffer_load_dwordx4 v7, s[36:39], s65 offen offset:1024 nt lds
  s_waitcnt vmcnt(6)
  s_cmp_ge_u32 s69, 2
  s_cbranch_scc1 L_ad179
  s_waitcnt vmcnt(5)
  s_cmp_ge_u32 s69, 1
  s_cbranch_scc1 L_ad179
  s_waitcnt vmcnt(4)
L_ad179:
  buffer_load_dwordx4 v6, s[36:39], s65 offen offset:2048 nt lds
  s_waitcnt vmcnt(6)
  s_cmp_ge_u32 s69, 2
  s_cbranch_scc1 L_ad180
  s_waitcnt vmcnt(5)
  s_cmp_ge_u32 s69, 1
  s_cbranch_scc1 L_ad180
  s_waitcnt vmcnt(4)
L_ad180:
  buffer_load_dwordx4 v7, s[36:39], s65 offen offset:3072 nt lds
  ds_read_b64_tr_b16 v[146:147], v12 offset:20480
  ds_read_b64_tr_b16 v[150:151], v13 offset:20480
  ds_read_b64_tr_b16 v[154:155], v14 offset:20480
  ds_read_b64_tr_b16 v[158:159], v15 offset:20480
  ds_read_b64_tr_b16 v[162:163], v16 offset:20480
  ds_read_b64_tr_b16 v[166:167], v17 offset:20480
  ds_read_b64_tr_b16 v[170:171], v18 offset:20480
  ds_read_b64_tr_b16 v[174:175], v19 offset:20480
  s_waitcnt lgkmcnt(7)
  v_mfma_f32_16x16x32_bf16 v[208:211], v[240:243], v[144:147], v[208:211]
  s_waitcnt lgkmcnt(6)
  v_mfma_f32_16x16x32_bf16 v[212:215], v[240:243], v[148:151], v[212:215]
  s_waitcnt lgkmcnt(5)
  v_mfma_f32_16x16x32_bf16 v[216:219], v[240:243], v[152:155], v[216:219]
  s_waitcnt lgkmcnt(4)
  v_mfma_f32_16x16x32_bf16 v[220:223], v[240:243], v[156:159], v[220:223]
  s_waitcnt lgkmcnt(3)
  v_mfma_f32_16x16x32_bf16 v[224:227], v[240:243], v[160:163], v[224:227]
  s_waitcnt lgkmcnt(2)
  v_mfma_f32_16x16x32_bf16 v[228:231], v[240:243], v[164:167], v[228:231]
  s_waitcnt lgkmcnt(1)
  v_mfma_f32_16x16x32_bf16 v[232:235], v[240:243], v[168:171], v[232:235]
  s_waitcnt lgkmcnt(0)
  v_mfma_f32_16x16x32_bf16 v[236:239], v[240:243], v[172:175], v[236:239]
  s_waitcnt vmcnt(4)
  s_mov_b32 s77, 0
  buffer_load_dwordx2 v[32:33], v20, s[40:43], s77 offen nt
  s_mov_b32 s77, 131072
  buffer_load_dwordx2 v[34:35], v20, s[40:43], s77 offen nt
  s_mov_b32 s77, 1024
  buffer_load_dwordx2 v[36:37], v20, s[40:43], s77 offen nt
  s_mov_b32 s77, 132096
  buffer_load_dwordx2 v[38:39], v20, s[40:43], s77 offen nt
  s_mov_b32 s77, 2048
  buffer_load_dwordx2 v[40:41], v20, s[40:43], s77 offen nt
  s_mov_b32 s77, 133120
  buffer_load_dwordx2 v[42:43], v20, s[40:43], s77 offen nt
  s_mov_b32 s77, 3072
  buffer_load_dwordx2 v[44:45], v20, s[40:43], s77 offen nt
  s_mov_b32 s77, 134144
  buffer_load_dwordx2 v[46:47], v20, s[40:43], s77 offen nt
  s_mov_b32 s77, 4096
  buffer_load_dwordx2 v[48:49], v20, s[40:43], s77 offen nt
  s_mov_b32 s77, 135168
  buffer_load_dwordx2 v[50:51], v20, s[40:43], s77 offen nt
  s_mov_b32 s77, 5120
  buffer_load_dwordx2 v[52:53], v20, s[40:43], s77 offen nt
  s_mov_b32 s77, 136192
  buffer_load_dwordx2 v[54:55], v20, s[40:43], s77 offen nt
  s_mov_b32 s77, 6144
  buffer_load_dwordx2 v[56:57], v20, s[40:43], s77 offen nt
  s_mov_b32 s77, 137216
  buffer_load_dwordx2 v[58:59], v20, s[40:43], s77 offen nt
  s_mov_b32 s77, 7168
  buffer_load_dwordx2 v[60:61], v20, s[40:43], s77 offen nt
  s_mov_b32 s77, 138240
  buffer_load_dwordx2 v[62:63], v20, s[40:43], s77 offen nt
  ds_read_b64_tr_b16 v[176:177], v12 offset:24576
  ds_read_b64_tr_b16 v[180:181], v13 offset:24576
  ds_read_b64_tr_b16 v[184:185], v14 offset:24576
  ds_read_b64_tr_b16 v[188:189], v15 offset:24576
  ds_read_b64_tr_b16 v[192:193], v16 offset:24576
  ds_read_b64_tr_b16 v[196:197], v17 offset:24576
  ds_read_b64_tr_b16 v[200:201], v18 offset:24576
  ds_read_b64_tr_b16 v[204:205], v19 offset:24576
  v_mov_b32_dpp v244, v140 row_shl:12 row_mask:0xf bank_mask:0xf bound_ctrl:0
  v_mov_b32_dpp v245, v141 row_shl:12 row_mask:0xf bank_mask:0xf bound_ctrl:0
  v_mov_b32_dpp v246, v142 row_shl:12 row_mask:0xf bank_mask:0xf bound_ctrl:0
  v_mov_b32_dpp v247, v143 row_shl:12 row_mask:0xf bank_mask:0xf bound_ctrl:0
  s_waitcnt vmcnt(16)
  ds_read_b64_tr_b16 v[178:179], v12 offset:28672
  ds_read_b64_tr_b16 v[182:183], v13 offset:28672
  ds_read_b64_tr_b16 v[186:187], v14 offset:28672
  ds_read_b64_tr_b16 v[190:191], v15 offset:28672
  ds_read_b64_tr_b16 v[194:195], v16 offset:28672
  ds_read_b64_tr_b16 v[198:199], v17 offset:28672
  ds_read_b64_tr_b16 v[202:203], v18 offset:28672
  ds_read_b64_tr_b16 v[206:207], v19 offset:28672
  s_waitcnt lgkmcnt(7)
  v_mfma_f32_16x16x32_bf16 v[208:211], v[244:247], v[176:179], v[208:211]
  s_waitcnt lgkmcnt(6)
  v_mfma_f32_16x16x32_bf16 v[212:215], v[244:247], v[180:183], v[212:215]
  s_waitcnt lgkmcnt(5)
  v_mfma_f32_16x16x32_bf16 v[216:219], v[244:247], v[184:187], v[216:219]
  s_waitcnt lgkmcnt(4)
  v_mfma_f32_16x16x32_bf16 v[220:223], v[244:247], v[188:191], v[220:223]
  s_waitcnt lgkmcnt(3)
  v_mfma_f32_16x16x32_bf16 v[224:227], v[244:247], v[192:195], v[224:227]
  s_waitcnt lgkmcnt(2)
  v_mfma_f32_16x16x32_bf16 v[228:231], v[244:247], v[196:199], v[228:231]
  s_waitcnt lgkmcnt(1)
  v_mfma_f32_16x16x32_bf16 v[232:235], v[244:247], v[200:203], v[232:235]
  s_waitcnt lgkmcnt(0)
  v_mfma_f32_16x16x32_bf16 v[236:239], v[244:247], v[204:207], v[236:239]
  s_nop 3
  s_mov_b64 exec, 0xffff
  ds_write_b128 v25, v[208:211] offset:0
  ds_write_b128 v25, v[212:215] offset:256
  ds_write_b128 v25, v[216:219] offset:512
  ds_write_b128 v25, v[220:223] offset:768
  ds_write_b128 v25, v[224:227] offset:1024
  ds_write_b128 v25, v[228:231] offset:1280
  ds_write_b128 v25, v[232:235] offset:1536
  ds_write_b128 v25, v[236:239] offset:1792
  s_mov_b64 exec, -1
  s_waitcnt lgkmcnt(0)
  s_barrier
  s_cmp_ge_u32 s3, 2
  s_cbranch_scc1 L_skip_mb
  ds_read_b128 v[144:147], v26 offset:0
  ds_read_b128 v[148:151], v26 offset:2048
  ds_read_b128 v[152:155], v26 offset:4096
  ds_read_b128 v[156:159], v26 offset:6144
  s_waitcnt lgkmcnt(3)
  v_pk_mul_f32 v[144:145], v[144:145], v[96:97]
  v_pk_mul_f32 v[146:147], v[146:147], v[98:99]
  s_waitcnt lgkmcnt(2)
  v_pk_fma_f32 v[144:145], v[148:149], v[100:101], v[144:145]
  v_pk_fma_f32 v[146:147], v[150:151], v[102:103], v[146:147]
  s_waitcnt lgkmcnt(1)
  v_pk_fma_f32 v[144:145], v[152:153], v[104:105], v[144:145]
  v_pk_fma_f32 v[146:147], v[154:155], v[106:107], v[146:147]
  s_waitcnt lgkmcnt(0)
  v_pk_fma_f32 v[144:145], v[156:157], v[108:109], v[144:145]
  v_pk_fma_f32 v[146:147], v[158:159], v[110:111], v[146:147]
  v_bfi_b32 v144, s71, v252, v144
  v_bfi_b32 v145, s71, v252, v145
  v_bfi_b32 v146, s71, v252, v146
  v_bfi_b32 v147, s71, v252, v147
  buffer_store_dwordx4 v[144:147], v27, s[44:47], 0 offen sc1
  s_waitcnt vmcnt(1)
  s_branch L_wo_ready
L_skip_mb:
  s_waitcnt vmcnt(0)
L_wo_ready:
  s_nop 1
  v_perm_b32 v64, v34, v32, s80
  v_perm_b32 v65, v34, v32, s81
  v_perm_b32 v66, v35, v33, s80
  v_perm_b32 v67, v35, v33, s81
  v_perm_b32 v68, v38, v36, s80
  v_perm_b32 v69, v38, v36, s81
  v_perm_b32 v70, v39, v37, s80
  v_perm_b32 v71, v39, v37, s81
  v_perm_b32 v72, v42, v40, s80
  v_perm_b32 v73, v42, v40, s81
  v_perm_b32 v74, v43, v41, s80
  v_perm_b32 v75, v43, v41, s81
  v_perm_b32 v76, v46, v44, s80
  v_perm_b32 v77, v46, v44, s81
  v_perm_b32 v78, v47, v45, s80
  v_perm_b32 v79, v47, v45, s81
  v_perm_b32 v80, v50, v48, s80
  v_perm_b32 v81, v50, v48, s81
  v_perm_b32 v82, v51, v49, s80
  v_perm_b32 v83, v51, v49, s81
  v_perm_b32 v84, v54, v52, s80
  v_perm_b32 v85, v54, v52, s81
  v_perm_b32 v86, v55, v53, s80
  v_perm_b32 v87, v55, v53, s81
  v_perm_b32 v88, v58, v56, s80
  v_perm_b32 v89, v58, v56, s81
  v_perm_b32 v90, v59, v57, s80
  v_perm_b32 v91, v59, v57, s81
  v_perm_b32 v92, v62, v60, s80
  v_perm_b32 v93, v62, v60, s81
  v_perm_b32 v94, v63, v61, s80
  v_perm_b32 v95, v63, v61, s81
  s_sleep 12
  s_mov_b32 s70, 30000
  s_mov_b64 s[56:57], exec
L_poll_m:
  buffer_load_dwordx4 v[144:147], v21, s[44:47], 0 offen offset:0 sc1
  buffer_load_dwordx4 v[148:151], v21, s[44:47], 0 offen offset:1024 sc1
  s_waitcnt vmcnt(0)
  v_xor_b32 v144, s66, v144
  v_xor_b32 v145, s66, v145
  v_xor_b32 v146, s66, v146
  v_xor_b32 v147, s66, v147
  v_xor_b32 v148, s66, v148
  v_xor_b32 v149, s66, v149
  v_xor_b32 v150, s66, v150
  v_xor_b32 v151, s66, v151
  v_or3_b32 v30, v144, v145, v146
  v_or3_b32 v30, v30, v147, v148
  v_or3_b32 v30, v30, v149, v150
  v_or_b32 v30, v30, v151
  v_and_b32 v30, 1023, v30
  v_cmp_ne_u32 vcc, 0, v30
  s_nop 0
  s_and_b64 exec, exec, vcc
  s_cbranch_scc0 L_poll_m_done
  s_sub_u32 s70, s70, 1
  s_cmp_eq_u32 s70, 0
  s_cbranch_scc1 L_poll_m_done
  s_branch L_poll_m
L_poll_m_done:
  s_mov_b64 exec, s[56:57]
  s_nop 1
  v_pk_add_f32 v[144:145], v[144:145], v[148:149]
  v_pk_add_f32 v[146:147], v[146:147], v[150:151]
  s_nop 1
  v_permlane32_swap_b32 v144, v146
  v_permlane32_swap_b32 v145, v147
  v_add_f32 v168, v144, v146
  v_add_f32 v169, v145, v147
  v_mov_b32 v170, v168
  v_mov_b32 v171, v169
  s_nop 0
  v_permlane16_swap_b32 v168, v170
  v_permlane16_swap_b32 v169, v171
  v_add_f32 v168, v168, v170
  v_add_f32 v169, v169, v171
  s_nop 0
  v_add_f32_dpp v168, v168, v168 row_ror:8 row_mask:0xf bank_mask:0xf
  v_add_f32_dpp v169, v169, v169 row_ror:8 row_mask:0xf bank_mask:0xf
  v_cvt_pk_bf16_f32 v168, v168, v169
  s_nop 1
  v_mov_b32_dpp v176, v168 row_newbcast:0 row_mask:0xf bank_mask:0xf
  v_mov_b32_dpp v177, v168 row_newbcast:1 row_mask:0xf bank_mask:0xf
  v_mov_b32_dpp v178, v168 row_newbcast:2 row_mask:0xf bank_mask:0xf
  v_mov_b32_dpp v179, v168 row_newbcast:3 row_mask:0xf bank_mask:0xf
  v_mov_b32_dpp v180, v168 row_newbcast:4 row_mask:0xf bank_mask:0xf
  v_mov_b32_dpp v181, v168 row_newbcast:5 row_mask:0xf bank_mask:0xf
  v_mov_b32_dpp v182, v168 row_newbcast:6 row_mask:0xf bank_mask:0xf
  v_mov_b32_dpp v183, v168 row_newbcast:7 row_mask:0xf bank_mask:0xf
  v_dot2_f32_bf16 v184, v176, v64, 0
  v_dot2_f32_bf16 v185, v176, v65, 0
  v_dot2_f32_bf16 v186, v176, v66, 0
  v_dot2_f32_bf16 v187, v176, v67, 0
  v_dot2_f32_bf16 v184, v177, v68, v184
  v_dot2_f32_bf16 v185, v177, v69, v185
  v_dot2_f32_bf16 v186, v177, v70, v186
  v_dot2_f32_bf16 v187, v177, v71, v187
  v_dot2_f32_bf16 v184, v178, v72, v184
  v_dot2_f32_bf16 v185, v178, v73, v185
  v_dot2_f32_bf16 v186, v178, v74, v186
  v_dot2_f32_bf16 v187, v178, v75, v187
  v_dot2_f32_bf16 v184, v179, v76, v184
  v_dot2_f32_bf16 v185, v179, v77, v185
  v_dot2_f32_bf16 v186, v179, v78, v186
  v_dot2_f32_bf16 v187, v179, v79, v187
  v_dot2_f32_bf16 v184, v180, v80, v184
  v_dot2_f32_bf16 v185, v180, v81, v185
  v_dot2_f32_bf16 v186, v180, v82, v186
  v_dot2_f32_bf16 v187, v180, v83, v187
  v_dot2_f32_bf16 v184, v181, v84, v184
  v_dot2_f32_bf16 v185, v181, v85, v185
  v_dot2_f32_bf16 v186, v181, v86, v186
  v_dot2_f32_bf16 v187, v181, v87, v187
  v_dot2_f32_bf16 v184, v182, v88, v184
  v_dot2_f32_bf16 v185, v182, v89, v185
  v_dot2_f32_bf16 v186, v182, v90, v186
  v_dot2_f32_bf16 v187, v182, v91, v187
  v_dot2_f32_bf16 v184, v183, v92, v184
  v_dot2_f32_bf16 v185, v183, v93, v185
  v_dot2_f32_bf16 v186, v183, v94, v186
  v_dot2_f32_bf16 v187, v183, v95, v187
  s_nop 1
  v_permlane32_swap_b32 v184, v186
  v_permlane32_swap_b32 v185, v187
  v_add_f32 v184, v184, v186
  v_add_f32 v185, v185, v187
  v_bfi_b32 v184, s71, v252, v184
  v_bfi_b32 v185, s71, v252, v185
  buffer_store_dwordx2 v[184:185], v28, s[44:47], 0 offen sc1
  s_cmp_eq_u32 s3, 0
  s_cbranch_scc1 L_final
L_s_end:
  s_endpgm
L_final:
  v_lshrrev_b32 v25, 5, v1
  v_bfe_u32 v26, v1, 4, 1
  v_lshl_add_u32 v25, v26, 1, v25
  v_lshlrev_b32 v26, 2, v25
  v_add_u32 v26, 151056, v26
  ds_read_b32 v27, v26 offset:16
  s_lshr_b32 s79, s2, 7
  s_lshl_b32 s79, s79, 10
  s_and_b32 s82, s2, 127
  s_lshl_b32 s82, s82, 3
  s_add_u32 s79, s79, s82
  v_lshl_add_u32 v28, v25, 1, s79
  ds_read_b32 v25, v26
  s_sleep 24
  s_mov_b32 s70, 30000
  s_mov_b64 s[56:57], exec
L_poll_sp:
  buffer_load_dwordx4 v[144:147], v29, s[44:47], 0 offen sc1
  buffer_load_dwordx4 v[148:151], v29, s[44:47], s83 offen sc1
  s_waitcnt vmcnt(0)
  v_xor_b32 v144, s66, v144
  v_xor_b32 v145, s66, v145
  v_xor_b32 v146, s66, v146
  v_xor_b32 v147, s66, v147
  v_xor_b32 v148, s66, v148
  v_xor_b32 v149, s66, v149
  v_xor_b32 v150, s66, v150
  v_xor_b32 v151, s66, v151
  v_or3_b32 v30, v144, v145, v146
  v_or3_b32 v30, v30, v147, v148
  v_or3_b32 v30, v30, v149, v150
  v_or_b32 v30, v30, v151
  v_and_b32 v30, 1023, v30
  v_cmp_ne_u32 vcc, 0, v30
  s_nop 0
  s_and_b64 exec, exec, vcc
  s_cbranch_scc0 L_poll_sp_done
  s_sub_u32 s70, s70, 1
  s_cmp_eq_u32 s70, 0
  s_cbranch_scc1 L_poll_sp_done
  s_branch L_poll_sp
L_poll_sp_done:
  s_mov_b64 exec, s[56:57]
  s_nop 1
  s_waitcnt lgkmcnt(0)
  v_pk_add_f32 v[144:145], v[144:145], v[148:149]
  v_pk_add_f32 v[146:147], v[146:147], v[150:151]
  s_nop 0
  v_permlane32_swap_b32 v144, v145
  v_permlane32_swap_b32 v146, v147
  v_add_f32 v144, v144, v145
  v_add_f32 v146, v146, v147
  s_nop 1
  v_permlane16_swap_b32 v144, v146
  v_add_f32 v144, v144, v146
  s_nop 1
  v_add_f32_dpp v144, v144, v144 row_ror:8 row_mask:0xf bank_mask:0xf
  s_nop 1
  v_add_f32_dpp v144, v144, v144 row_ror:4 row_mask:0xf bank_mask:0xf
  s_nop 1
  v_add_f32_dpp v144, v144, v144 row_ror:2 row_mask:0xf bank_mask:0xf
  s_nop 1
  v_add_f32_dpp v144, v144, v144 row_ror:1 row_mask:0xf bank_mask:0xf
  v_cvt_pk_bf16_f32 v144, v144, v144
  v_lshlrev_b32 v144, 16, v144
  v_mul_f32 v144, v144, v25
  v_cvt_pk_bf16_f32 v144, v144, v144
  v_lshlrev_b32 v144, 16, v144
  v_add_f32 v144, v144, v27
  v_cvt_pk_bf16_f32 v144, v144, v144
  s_mov_b32 exec_lo, 0x00010001
  s_mov_b32 exec_hi, 0x00010001
  buffer_store_short v144, v28, s[48:51], 0 offen sc1
  s_mov_b64 exec, 1
  s_cmp_lg_u32 s2, 0
  s_cbranch_scc1 L_noepoch
  v_mov_b32 v25, 0
  buffer_store_dword v252, v25, s[44:47], 0 offen sc1
L_noepoch:
  s_mov_b64 exec, -1
  s_endpgm
L_helper:
  s_setprio 3
  s_waitcnt lgkmcnt(0)
  s_mov_b32 s32, s4
  s_and_b32 s33, s5, 0xffff
  s_mov_b32 s34, 0x800
  s_mov_b32 s35, 0x20000
  v_lshlrev_b32 v2, 4, v1
  buffer_load_dwordx4 v[8:11], v2, s[32:35], 0 offen
  buffer_load_dwordx4 v[12:15], v2, s[32:35], 0 offen offset:1024
  s_load_dword s66, s[28:29], 0
  s_mov_b32 s44, s28
  s_and_b32 s45, s29, 0xffff
  s_mov_b32 s46, 0x200000
  s_mov_b32 s47, 0x20000
  s_mov_b32 s40, s16
  s_and_b32 s41, s17, 0xffff
  s_mov_b32 s42, 0x1c0000
  s_mov_b32 s43, 0x20000
  s_mov_b32 s48, s18
  s_and_b32 s49, s19, 0xffff
  s_mov_b32 s50, 0xe00
  s_mov_b32 s51, 0x20000
  s_mov_b32 s52, s20
  s_and_b32 s53, s21, 0xffff
  s_mov_b32 s54, 0x1c0000
  s_mov_b32 s55, 0x20000
  s_mov_b32 s56, s22
  s_and_b32 s57, s23, 0xffff
  s_mov_b32 s58, 0x400
  s_mov_b32 s59, 0x20000
  s_mov_b32 s60, s24
  s_and_b32 s61, s25, 0xffff
  s_mov_b32 s62, 0x800
  s_mov_b32 s63, 0x20000
  s_lshr_b32 s67, s2, 4
  s_and_b32 s68, s2, 15
  s_lshr_b32 s71, s2, 7
  s_and_b32 s76, s2, 127
  s_lshl_b32 s69, s76, 2
  s_movk_i32 s73, 1023
  v_lshrrev_b32 v3, 2, v1
  v_lshlrev_b32 v4, 7, v3
  v_and_b32 v5, 1, v1
  v_lshl_add_u32 v4, v5, 3, v4
  v_add_u32 v4, 131072, v4
  v_lshrrev_b32 v3, 1, v3
  v_and_b32 v3, 3, v3
  v_lshlrev_b32 v3, 1, v3
  v_bfe_u32 v5, v1, 1, 1
  v_add_u32 v6, 0, v5
  v_xor_b32 v6, v6, v3
  v_lshl_add_u32 v80, v6, 4, v4
  v_add_u32 v6, 2, v5
  v_xor_b32 v6, v6, v3
  v_lshl_add_u32 v81, v6, 4, v4
  v_add_u32 v6, 4, v5
  v_xor_b32 v6, v6, v3
  v_lshl_add_u32 v82, v6, 4, v4
  v_add_u32 v6, 6, v5
  v_xor_b32 v6, v6, v3
  v_lshl_add_u32 v83, v6, 4, v4
  v_mov_b32 v84, 151040
  v_mov_b32 v88, 0
  v_mov_b32 v89, 0
  v_mov_b32 v90, 0
  v_mov_b32 v91, 0
  ds_write_b128 v84, v[88:91]
  v_mov_b32 v84, 151088
  v_mov_b32 v88, 1
  ds_write_b32 v84, v88
  v_mov_b32 v84, 151096
  ds_write_b64 v84, v[90:91]
  v_mov_b32 v84, 151104
  ds_write_b32 v84, v90
  s_waitcnt vmcnt(0)
  v_lshlrev_b32 v16, 16, v8
  v_and_b32 v17, 0xffff0000, v8
  v_lshlrev_b32 v18, 16, v9
  v_and_b32 v19, 0xffff0000, v9
  v_lshlrev_b32 v20, 16, v10
  v_and_b32 v21, 0xffff0000, v10
  v_lshlrev_b32 v22, 16, v11
  v_and_b32 v23, 0xffff0000, v11
  v_lshlrev_b32 v24, 16, v12
  v_and_b32 v25, 0xffff0000, v12
  v_lshlrev_b32 v26, 16, v13
  v_and_b32 v27, 0xffff0000, v13
  v_lshlrev_b32 v28, 16, v14
  v_and_b32 v29, 0xffff0000, v14
  v_lshlrev_b32 v30, 16, v15
  v_and_b32 v31, 0xffff0000, v15
  v_pk_add_f32 v[36:37], v[16:17], v[18:19]
  v_pk_add_f32 v[38:39], v[20:21], v[22:23]
  v_pk_add_f32 v[40:41], v[24:25], v[26:27]
  v_pk_add_f32 v[42:43], v[28:29], v[30:31]
  v_pk_add_f32 v[36:37], v[36:37], v[38:39]
  v_pk_add_f32 v[40:41], v[40:41], v[42:43]
  v_add_f32 v32, v36, v37
  v_add_f32 v33, v40, v41
  s_nop 0
  v_add_f32_dpp v32, v32, v32 row_ror:8 row_mask:0xf bank_mask:0xf
  v_add_f32_dpp v33, v33, v33 row_ror:8 row_mask:0xf bank_mask:0xf
  s_nop 0
  v_add_f32_dpp v32, v32, v32 row_ror:4 row_mask:0xf bank_mask:0xf
  v_add_f32_dpp v33, v33, v33 row_ror:4 row_mask:0xf bank_mask:0xf
  s_nop 0
  v_add_f32_dpp v32, v32, v32 row_ror:2 row_mask:0xf bank_mask:0xf
  v_add_f32_dpp v33, v33, v33 row_ror:2 row_mask:0xf bank_mask:0xf
  s_nop 0
  v_add_f32_dpp v32, v32, v32 row_ror:1 row_mask:0xf bank_mask:0xf
  v_add_f32_dpp v33, v33, v33 row_ror:1 row_mask:0xf bank_mask:0xf
  v_mov_b32 v34, v32
  v_mov_b32 v35, v33
  s_nop 0
  v_permlane16_swap_b32 v32, v34
  v_permlane16_swap_b32 v33, v35
  v_add_f32 v32, v32, v34
  v_add_f32 v33, v33, v35
  v_mov_b32 v34, v32
  v_mov_b32 v35, v33
  s_nop 0
  v_permlane32_swap_b32 v32, v34
  v_permlane32_swap_b32 v33, v35
  v_add_f32 v32, v32, v34
  v_add_f32 v33, v33, v35
  v_mul_f32 v32, 0x3b000000, v32
  v_mul_f32 v33, 0x3b000000, v33
  v_sub_f32 v36, v16, v32
  v_sub_f32 v44, v24, v33
  v_sub_f32 v37, v17, v32
  v_sub_f32 v45, v25, v33
  v_sub_f32 v38, v18, v32
  v_sub_f32 v46, v26, v33
  v_sub_f32 v39, v19, v32
  v_sub_f32 v47, v27, v33
  v_sub_f32 v40, v20, v32
  v_sub_f32 v48, v28, v33
  v_sub_f32 v41, v21, v32
  v_sub_f32 v49, v29, v33
  v_sub_f32 v42, v22, v32
  v_sub_f32 v50, v30, v33
  v_sub_f32 v43, v23, v32
  v_sub_f32 v51, v31, v33
  v_pk_mul_f32 v[54:55], v[36:37], v[36:37]
  v_pk_mul_f32 v[56:57], v[44:45], v[44:45]
  v_pk_fma_f32 v[54:55], v[38:39], v[38:39], v[54:55]
  v_pk_fma_f32 v[56:57], v[46:47], v[46:47], v[56:57]
  v_pk_fma_f32 v[54:55], v[40:41], v[40:41], v[54:55]
  v_pk_fma_f32 v[56:57], v[48:49], v[48:49], v[56:57]
  v_pk_fma_f32 v[54:55], v[42:43], v[42:43], v[54:55]
  v_pk_fma_f32 v[56:57], v[50:51], v[50:51], v[56:57]
  v_add_f32 v52, v54, v55
  v_add_f32 v53, v56, v57
  s_nop 0
  v_add_f32_dpp v52, v52, v52 row_ror:8 row_mask:0xf bank_mask:0xf
  v_add_f32_dpp v53, v53, v53 row_ror:8 row_mask:0xf bank_mask:0xf
  s_nop 0
  v_add_f32_dpp v52, v52, v52 row_ror:4 row_mask:0xf bank_mask:0xf
  v_add_f32_dpp v53, v53, v53 row_ror:4 row_mask:0xf bank_mask:0xf
  s_nop 0
  v_add_f32_dpp v52, v52, v52 row_ror:2 row_mask:0xf bank_mask:0xf
  v_add_f32_dpp v53, v53, v53 row_ror:2 row_mask:0xf bank_mask:0xf
  s_nop 0
  v_add_f32_dpp v52, v52, v52 row_ror:1 row_mask:0xf bank_mask:0xf
  v_add_f32_dpp v53, v53, v53 row_ror:1 row_mask:0xf bank_mask:0xf
  v_mov_b32 v34, v52
  v_mov_b32 v35, v53
  s_nop 0
  v_permlane16_swap_b32 v52, v34
  v_permlane16_swap_b32 v53, v35
  v_add_f32 v52, v52, v34
  v_add_f32 v53, v53, v35
  v_mov_b32 v34, v52
  v_mov_b32 v35, v53
  s_nop 0
  v_permlane32_swap_b32 v52, v34
  v_permlane32_swap_b32 v53, v35
  v_add_f32 v52, v52, v34
  v_add_f32 v53, v53, v35
  v_mul_f32 v52, 0x3b000000, v52
  v_mul_f32 v53, 0x3b000000, v53
  v_cvt_pk_bf16_f32 v54, v32, v33
  v_cvt_pk_bf16_f32 v55, v52, v53
  v_lshlrev_b32 v32, 16, v54
  v_and_b32 v33, 0xffff0000, v54
  v_lshlrev_b32 v52, 16, v55
  v_and_b32 v53, 0xffff0000, v55
  v_add_f32 v52, 0x3727c5ac, v52
  v_add_f32 v53, 0x3727c5ac, v53
  v_cvt_pk_bf16_f32 v55, v52, v53
  v_lshlrev_b32 v52, 16, v55
  v_and_b32 v53, 0xffff0000, v55
  v_sqrt_f32 v52, v52
  v_sqrt_f32 v53, v53
  v_sub_f32 v16, v16, v32
  v_sub_f32 v17, v17, v32
  v_sub_f32 v18, v18, v32
  v_sub_f32 v19, v19, v32
  v_sub_f32 v20, v20, v32
  v_sub_f32 v21, v21, v32
  v_sub_f32 v22, v22, v32
  v_sub_f32 v23, v23, v32
  v_sub_f32 v24, v24, v33
  v_sub_f32 v25, v25, v33
  v_sub_f32 v26, v26, v33
  v_sub_f32 v27, v27, v33
  v_sub_f32 v28, v28, v33
  v_sub_f32 v29, v29, v33
  v_sub_f32 v30, v30, v33
  v_sub_f32 v31, v31, v33
  v_cvt_pk_bf16_f32 v55, v52, v53
  v_lshlrev_b32 v52, 16, v55
  v_and_b32 v53, 0xffff0000, v55
  v_rcp_f32 v56, v52
  v_rcp_f32 v58, v53
  v_cvt_pk_bf16_f32 v8, v16, v17
  v_cvt_pk_bf16_f32 v9, v18, v19
  v_cvt_pk_bf16_f32 v10, v20, v21
  v_cvt_pk_bf16_f32 v11, v22, v23
  v_cvt_pk_bf16_f32 v12, v24, v25
  v_cvt_pk_bf16_f32 v13, v26, v27
  v_cvt_pk_bf16_f32 v14, v28, v29
  v_cvt_pk_bf16_f32 v15, v30, v31
  v_mov_b32 v57, v56
  v_mov_b32 v59, v58
  v_mov_b32 v60, v52
  v_mov_b32 v61, v52
  v_mov_b32 v54, v53
  v_mov_b32 v55, v53
  v_lshlrev_b32 v16, 16, v8
  v_and_b32 v17, 0xffff0000, v8
  v_lshlrev_b32 v18, 16, v9
  v_and_b32 v19, 0xffff0000, v9
  v_lshlrev_b32 v20, 16, v10
  v_and_b32 v21, 0xffff0000, v10
  v_lshlrev_b32 v22, 16, v11
  v_and_b32 v23, 0xffff0000, v11
  v_lshlrev_b32 v24, 16, v12
  v_and_b32 v25, 0xffff0000, v12
  v_lshlrev_b32 v26, 16, v13
  v_and_b32 v27, 0xffff0000, v13
  v_lshlrev_b32 v28, 16, v14
  v_and_b32 v29, 0xffff0000, v14
  v_lshlrev_b32 v30, 16, v15
  v_and_b32 v31, 0xffff0000, v15
  v_pk_mul_f32 v[36:37], v[16:17], v[56:57]
  v_pk_mul_f32 v[38:39], v[18:19], v[56:57]
  v_pk_mul_f32 v[40:41], v[20:21], v[56:57]
  v_pk_mul_f32 v[42:43], v[22:23], v[56:57]
  v_pk_mul_f32 v[44:45], v[24:25], v[58:59]
  v_pk_mul_f32 v[46:47], v[26:27], v[58:59]
  v_pk_mul_f32 v[48:49], v[28:29], v[58:59]
  v_pk_mul_f32 v[50:51], v[30:31], v[58:59]
  v_pk_fma_f32 v[16:17], v[36:37], v[60:61], v[16:17] neg_lo:[1,0,0] neg_hi:[1,0,0]
  v_pk_fma_f32 v[18:19], v[38:39], v[60:61], v[18:19] neg_lo:[1,0,0] neg_hi:[1,0,0]
  v_pk_fma_f32 v[20:21], v[40:41], v[60:61], v[20:21] neg_lo:[1,0,0] neg_hi:[1,0,0]
  v_pk_fma_f32 v[22:23], v[42:43], v[60:61], v[22:23] neg_lo:[1,0,0] neg_hi:[1,0,0]
  v_pk_fma_f32 v[24:25], v[44:45], v[54:55], v[24:25] neg_lo:[1,0,0] neg_hi:[1,0,0]
  v_pk_fma_f32 v[26:27], v[46:47], v[54:55], v[26:27] neg_lo:[1,0,0] neg_hi:[1,0,0]
  v_pk_fma_f32 v[28:29], v[48:49], v[54:55], v[28:29] neg_lo:[1,0,0] neg_hi:[1,0,0]
  v_pk_fma_f32 v[30:31], v[50:51], v[54:55], v[30:31] neg_lo:[1,0,0] neg_hi:[1,0,0]
  v_pk_fma_f32 v[16:17], v[16:17], v[56:57], v[36:37]
  v_pk_fma_f32 v[18:19], v[18:19], v[56:57], v[38:39]
  v_pk_fma_f32 v[20:21], v[20:21], v[56:57], v[40:41]
  v_pk_fma_f32 v[22:23], v[22:23], v[56:57], v[42:43]
  v_pk_fma_f32 v[24:25], v[24:25], v[58:59], v[44:45]
  v_pk_fma_f32 v[26:27], v[26:27], v[58:59], v[46:47]
  v_pk_fma_f32 v[28:29], v[28:29], v[58:59], v[48:49]
  v_pk_fma_f32 v[30:31], v[30:31], v[58:59], v[50:51]
  v_cvt_pk_bf16_f32 v8, v16, v17
  v_cvt_pk_bf16_f32 v9, v18, v19
  v_cvt_pk_bf16_f32 v10, v20, v21
  v_cvt_pk_bf16_f32 v11, v22, v23
  v_cvt_pk_bf16_f32 v12, v24, v25
  v_cvt_pk_bf16_f32 v13, v26, v27
  v_cvt_pk_bf16_f32 v14, v28, v29
  v_cvt_pk_bf16_f32 v15, v30, v31
  v_lshlrev_b32 v2, 4, v1
  v_add_u32 v2, 147456, v2
  ds_write_b128 v2, v[8:11]
  ds_write_b128 v2, v[12:15] offset:1024
  v_and_b32 v3, 1, v1
  v_lshlrev_b32 v3, 10, v3
  v_lshrrev_b32 v4, 4, v1
  v_lshl_add_u32 v3, v4, 3, v3
  s_and_b32 s76, s2, 3
  s_lshl_b32 s76, s76, 8
  s_add_u32 s76, s76, 147456
  v_add_u32 v3, s76, v3
  s_waitcnt lgkmcnt(0)
  ds_read2_b64 v[64:67], v3 offset0:0 offset1:4
  ds_read2_b64 v[68:71], v3 offset0:8 offset1:12
  ds_read2_b64 v[72:75], v3 offset0:16 offset1:20
  ds_read2_b64 v[76:79], v3 offset0:24 offset1:28
  s_mul_i32 s66, s66, 0x9E3779B1
  s_add_u32 s66, s66, 0x7F4A7C15
  v_mov_b32 v63, s66
  s_and_b32 s74, s66, 1023
  s_lshl_b32 s76, s2, 8
  s_add_u32 s76, s76, 4096
  v_lshlrev_b32 v8, 2, v1
  v_add_u32 v8, s76, v8
  s_mov_b32 s77, 65536
  s_waitcnt lgkmcnt(0)
  s_barrier
  ds_read_b64_tr_b16 v[128:129], v80 offset:0
  ds_read_b64_tr_b16 v[130:131], v80 offset:2048
  ds_read_b64_tr_b16 v[132:133], v81 offset:0
  ds_read_b64_tr_b16 v[134:135], v81 offset:2048
  ds_read_b64_tr_b16 v[136:137], v82 offset:0
  ds_read_b64_tr_b16 v[138:139], v82 offset:2048
  ds_read_b64_tr_b16 v[140:141], v83 offset:0
  ds_read_b64_tr_b16 v[142:143], v83 offset:2048
  ds_read_b64_tr_b16 v[144:145], v80 offset:4096
  ds_read_b64_tr_b16 v[146:147], v80 offset:6144
  ds_read_b64_tr_b16 v[148:149], v81 offset:4096
  ds_read_b64_tr_b16 v[150:151], v81 offset:6144
  ds_read_b64_tr_b16 v[152:153], v82 offset:4096
  ds_read_b64_tr_b16 v[154:155], v82 offset:6144
  s_waitcnt lgkmcnt(12)
  v_mfma_f32_16x16x32_bf16 v[96:99], v[64:67], v[128:131], 0
  ds_read_b64_tr_b16 v[156:157], v83 offset:4096
  ds_read_b64_tr_b16 v[158:159], v83 offset:6144
  s_waitcnt lgkmcnt(12)
  v_mfma_f32_16x16x32_bf16 v[100:103], v[64:67], v[132:135], 0
  ds_read_b64_tr_b16 v[160:161], v80 offset:8192
  ds_read_b64_tr_b16 v[162:163], v80 offset:10240
  s_waitcnt lgkmcnt(12)
  v_mfma_f32_16x16x32_bf16 v[104:107], v[64:67], v[136:139], 0
  ds_read_b64_tr_b16 v[164:165], v81 offset:8192
  ds_read_b64_tr_b16 v[166:167], v81 offset:10240
  s_waitcnt lgkmcnt(12)
  v_mfma_f32_16x16x32_bf16 v[108:111], v[64:67], v[140:143], 0
  ds_read_b64_tr_b16 v[168:169], v82 offset:8192
  ds_read_b64_tr_b16 v[170:171], v82 offset:10240
  s_waitcnt lgkmcnt(12)
  v_mfma_f32_16x16x32_bf16 v[96:99], v[68:71], v[144:147], v[96:99]
  ds_read_b64_tr_b16 v[172:173], v83 offset:8192
  ds_read_b64_tr_b16 v[174:175], v83 offset:10240
  s_waitcnt lgkmcnt(12)
  v_mfma_f32_16x16x32_bf16 v[100:103], v[68:71], v[148:151], v[100:103]
  ds_read_b64_tr_b16 v[176:177], v80 offset:12288
  ds_read_b64_tr_b16 v[178:179], v80 offset:14336
  s_waitcnt lgkmcnt(12)
  v_mfma_f32_16x16x32_bf16 v[104:107], v[68:71], v[152:155], v[104:107]
  ds_read_b64_tr_b16 v[180:181], v81 offset:12288
  ds_read_b64_tr_b16 v[182:183], v81 offset:14336
  s_waitcnt lgkmcnt(12)
  v_mfma_f32_16x16x32_bf16 v[108:111], v[68:71], v[156:159], v[108:111]
  ds_read_b64_tr_b16 v[184:185], v82 offset:12288
  ds_read_b64_tr_b16 v[186:187], v82 offset:14336
  s_waitcnt lgkmcnt(12)
  v_mfma_f32_16x16x32_bf16 v[96:99], v[72:75], v[160:163], v[96:99]
  ds_read_b64_tr_b16 v[188:189], v83 offset:12288
  ds_read_b64_tr_b16 v[190:191], v83 offset:14336
  s_waitcnt lgkmcnt(12)
  v_mfma_f32_16x16x32_bf16 v[100:103], v[72:75], v[164:167], v[100:103]
  s_waitcnt lgkmcnt(10)
  v_mfma_f32_16x16x32_bf16 v[104:107], v[72:75], v[168:171], v[104:107]
  s_waitcnt lgkmcnt(8)
  v_mfma_f32_16x16x32_bf16 v[108:111], v[72:75], v[172:175], v[108:111]
  s_waitcnt lgkmcnt(6)
  v_mfma_f32_16x16x32_bf16 v[96:99], v[76:79], v[176:179], v[96:99]
  s_waitcnt lgkmcnt(4)
  v_mfma_f32_16x16x32_bf16 v[100:103], v[76:79], v[180:183], v[100:103]
  s_waitcnt lgkmcnt(2)
  v_mfma_f32_16x16x32_bf16 v[104:107], v[76:79], v[184:187], v[104:107]
  s_waitcnt lgkmcnt(0)
  v_mfma_f32_16x16x32_bf16 v[108:111], v[76:79], v[188:191], v[108:111]
  s_nop 3
  v_permlane16_swap_b32 v96, v100
  s_nop 2
  v_permlane16_swap_b32 v104, v108
  v_permlane16_swap_b32 v97, v101
  v_permlane16_swap_b32 v105, v109
  v_permlane32_swap_b32 v96, v104
  s_nop 0
  v_permlane32_swap_b32 v97, v105
  v_bfi_b32 v4, s73, v63, v96
  v_bfi_b32 v5, s73, v63, v97
  buffer_store_dword v4, v8, s[44:47], 0 offen sc1
  buffer_store_dword v5, v8, s[44:47], s77 offen sc1
  s_lshl_b32 s76, s2, 19
  s_add_u32 s84, s8, s76
  s_addc_u32 s85, s9, 0
  s_and_b32 s85, s85, 0xffff
  s_mov_b32 s86, 0x80000
  s_mov_b32 s87, 0x20000
  v_mul_u32_u24 v92, 524288, v1
  s_mov_b64 exec, 0x1
  buffer_load_dword v93, v92, s[84:87], 0 offen nt
  s_mov_b64 exec, 1
  s_mov_b32 s84, s12
  s_and_b32 s85, s13, 0xffff
  s_mov_b32 s86, 0x400000
  s_and_b32 s76, s67, 7
  s_lshl_b32 s76, s76, 19
  v_mov_b32 v92, s76
  buffer_load_dword v94, v92, s[84:87], 0 offen
  s_mov_b64 exec, -1
  s_lshl_b32 s76, s67, 13
  s_add_u32 s76, s76, 4096
  v_lshlrev_b32 v8, 4, v1
  v_add_u32 v8, s76, v8
  s_mov_b32 s80, 0x05040100
  s_mov_b32 s81, 0x07060302
  s_mov_b32 s78, 4096
  v_mov_b32 v10, 150528
  ds_write_b32 v10, v63
  v_lshrrev_b32 v9, 4, v1
  v_lshlrev_b32 v9, 8, v9
  v_and_b32 v10, 15, v1
  v_lshl_add_u32 v9, v10, 3, v9
  v_add_u32 v9, 149504, v9
  s_mov_b32 s70, 30000
  s_mov_b64 s[82:83], exec
  s_sleep 16
L_poll_q:
  buffer_load_dwordx4 v[128:131], v8, s[44:47], 0 offen offset:0 sc1
  buffer_load_dwordx4 v[132:135], v8, s[44:47], 0 offen offset:1024 sc1
  buffer_load_dwordx4 v[136:139], v8, s[44:47], 0 offen offset:2048 sc1
  buffer_load_dwordx4 v[140:143], v8, s[44:47], 0 offen offset:3072 sc1
  buffer_load_dwordx4 v[144:147], v8, s[44:47], s78 offen offset:0 sc1
  buffer_load_dwordx4 v[148:151], v8, s[44:47], s78 offen offset:1024 sc1
  buffer_load_dwordx4 v[152:155], v8, s[44:47], s78 offen offset:2048 sc1
  buffer_load_dwordx4 v[156:159], v8, s[44:47], s78 offen offset:3072 sc1
  s_waitcnt vmcnt(0)
  v_xor_b32 v128, s74, v128
  v_xor_b32 v129, s74, v129
  v_xor_b32 v130, s74, v130
  v_xor_b32 v131, s74, v131
  v_xor_b32 v132, s74, v132
  v_xor_b32 v133, s74, v133
  v_xor_b32 v134, s74, v134
  v_xor_b32 v135, s74, v135
  v_xor_b32 v136, s74, v136
  v_xor_b32 v137, s74, v137
  v_xor_b32 v138, s74, v138
  v_xor_b32 v139, s74, v139
  v_xor_b32 v140, s74, v140
  v_xor_b32 v141, s74, v141
  v_xor_b32 v142, s74, v142
  v_xor_b32 v143, s74, v143
  v_xor_b32 v144, s74, v144
  v_xor_b32 v145, s74, v145
  v_xor_b32 v146, s74, v146
  v_xor_b32 v147, s74, v147
  v_xor_b32 v148, s74, v148
  v_xor_b32 v149, s74, v149
  v_xor_b32 v150, s74, v150
  v_xor_b32 v151, s74, v151
  v_xor_b32 v152, s74, v152
  v_xor_b32 v153, s74, v153
  v_xor_b32 v154, s74, v154
  v_xor_b32 v155, s74, v155
  v_xor_b32 v156, s74, v156
  v_xor_b32 v157, s74, v157
  v_xor_b32 v158, s74, v158
  v_xor_b32 v159, s74, v159
  v_or3_b32 v32, v128, v129, v130
  v_or3_b32 v32, v32, v131, v132
  v_or3_b32 v32, v32, v133, v134
  v_or3_b32 v32, v32, v135, v136
  v_or3_b32 v32, v32, v137, v138
  v_or3_b32 v32, v32, v139, v140
  v_or3_b32 v32, v32, v141, v142
  v_or3_b32 v32, v32, v143, v144
  v_or3_b32 v32, v32, v145, v146
  v_or3_b32 v32, v32, v147, v148
  v_or3_b32 v32, v32, v149, v150
  v_or3_b32 v32, v32, v151, v152
  v_or3_b32 v32, v32, v153, v154
  v_or3_b32 v32, v32, v155, v156
  v_or3_b32 v32, v32, v157, v158
  v_or_b32 v32, v32, v159
  v_and_b32 v32, 1023, v32
  v_cmp_ne_u32 vcc, 0, v32
  s_nop 0
  s_and_b64 exec, exec, vcc
  s_cbranch_scc0 L_poll_q_done
  s_sub_u32 s70, s70, 1
  s_cmp_eq_u32 s70, 0
  s_cbranch_scc1 L_poll_q_done
  s_sleep 1
  s_branch L_poll_q
L_poll_q_done:
  s_mov_b64 exec, s[82:83]
  s_nop 1
  v_permlane32_swap_b32 v128, v144
  v_permlane32_swap_b32 v129, v145
  v_permlane32_swap_b32 v130, v146
  v_permlane32_swap_b32 v131, v147
  v_permlane32_swap_b32 v132, v148
  v_permlane32_swap_b32 v133, v149
  v_permlane32_swap_b32 v134, v150
  v_permlane32_swap_b32 v135, v151
  v_permlane32_swap_b32 v136, v152
  v_permlane32_swap_b32 v137, v153
  v_permlane32_swap_b32 v138, v154
  v_permlane32_swap_b32 v139, v155
  v_permlane32_swap_b32 v140, v156
  v_permlane32_swap_b32 v141, v157
  v_permlane32_swap_b32 v142, v158
  v_permlane32_swap_b32 v143, v159
  v_pk_add_f32 v[128:129], v[128:129], v[144:145]
  v_pk_add_f32 v[130:131], v[130:131], v[146:147]
  v_pk_add_f32 v[132:133], v[132:133], v[148:149]
  v_pk_add_f32 v[134:135], v[134:135], v[150:151]
  v_pk_add_f32 v[136:137], v[136:137], v[152:153]
  v_pk_add_f32 v[138:139], v[138:139], v[154:155]
  v_pk_add_f32 v[140:141], v[140:141], v[156:157]
  v_pk_add_f32 v[142:143], v[142:143], v[158:159]
  v_permlane16_swap_b32 v128, v136
  v_permlane16_swap_b32 v129, v137
  v_permlane16_swap_b32 v130, v138
  v_permlane16_swap_b32 v131, v139
  v_permlane16_swap_b32 v132, v140
  v_permlane16_swap_b32 v133, v141
  v_permlane16_swap_b32 v134, v142
  v_permlane16_swap_b32 v135, v143
  v_pk_add_f32 v[128:129], v[128:129], v[136:137]
  v_pk_add_f32 v[130:131], v[130:131], v[138:139]
  v_pk_add_f32 v[132:133], v[132:133], v[140:141]
  v_pk_add_f32 v[134:135], v[134:135], v[142:143]
  v_cvt_pk_bf16_f32 v16, v128, v129
  v_cvt_pk_bf16_f32 v17, v130, v131
  v_cvt_pk_bf16_f32 v18, v132, v133
  v_cvt_pk_bf16_f32 v19, v134, v135
  ds_write_b64 v9, v[16:17]
  ds_write_b64 v9, v[18:19] offset:128
  s_waitcnt lgkmcnt(0)
  v_mov_b32 v10, 151048
  v_mov_b32 v11, 1
  ds_write_b32 v10, v11
  s_setprio 0
  s_and_b32 s76, s2, 127
  s_cmp_ge_u32 s76, 112
  s_cbranch_scc1 L_no_h
  s_cmp_ge_u32 s2, 128
  s_cbranch_scc1 L_ffn_b
  v_lshrrev_b32 v3, 3, v1
  v_mul_u32_u24 v3, 3584, v3
  v_bfe_u32 v4, v1, 4, 2
  v_lshlrev_b32 v4, 1, v4
  v_and_b32 v5, 7, v1
  v_xor_b32 v5, v5, v4
  v_lshl_add_u32 v5, v5, 4, v3
  s_lshr_b32 s75, s2, 2
  s_lshl_b32 s75, s75, 7
  s_and_b32 s76, s2, 3
  s_mul_i32 s76, s76, 458752
  s_add_u32 s75, s75, s76
  v_add_u32 v5, s75, v5
  s_mov_b32 m0, 131072
  s_mov_b32 s77, 0
  buffer_load_dwordx4 v5, s[40:43], s77 offen nt lds
  s_mov_b32 m0, 132096
  s_mov_b32 s77, 28672
  buffer_load_dwordx4 v5, s[40:43], s77 offen nt lds
  s_mov_b32 m0, 133120
  s_mov_b32 s77, 57344
  buffer_load_dwordx4 v5, s[40:43], s77 offen nt lds
  s_mov_b32 m0, 134144
  s_mov_b32 s77, 86016
  buffer_load_dwordx4 v5, s[40:43], s77 offen nt lds
  s_mov_b32 m0, 135168
  s_mov_b32 s77, 114688
  buffer_load_dwordx4 v5, s[40:43], s77 offen nt lds
  s_mov_b32 m0, 136192
  s_mov_b32 s77, 143360
  buffer_load_dwordx4 v5, s[40:43], s77 offen nt lds
  s_mov_b32 m0, 137216
  s_mov_b32 s77, 172032
  buffer_load_dwordx4 v5, s[40:43], s77 offen nt lds
  s_mov_b32 m0, 138240
  s_mov_b32 s77, 200704
  buffer_load_dwordx4 v5, s[40:43], s77 offen nt lds
  s_mov_b32 m0, 139264
  s_mov_b32 s77, 229376
  buffer_load_dwordx4 v5, s[40:43], s77 offen nt lds
  s_mov_b32 m0, 140288
  s_mov_b32 s77, 258048
  buffer_load_dwordx4 v5, s[40:43], s77 offen nt lds
  s_mov_b32 m0, 141312
  s_mov_b32 s77, 286720
  buffer_load_dwordx4 v5, s[40:43], s77 offen nt lds
  s_mov_b32 m0, 142336
  s_mov_b32 s77, 315392
  buffer_load_dwordx4 v5, s[40:43], s77 offen nt lds
  s_mov_b32 m0, 143360
  s_mov_b32 s77, 344064
  buffer_load_dwordx4 v5, s[40:43], s77 offen nt lds
  s_mov_b32 m0, 144384
  s_mov_b32 s77, 372736
  buffer_load_dwordx4 v5, s[40:43], s77 offen nt lds
  s_mov_b32 m0, 145408
  s_mov_b32 s77, 401408
  buffer_load_dwordx4 v5, s[40:43], s77 offen nt lds
  s_mov_b32 m0, 146432
  s_mov_b32 s77, 430080
  buffer_load_dwordx4 v5, s[40:43], s77 offen nt lds
  s_lshl_b32 s76, s2, 9
  s_add_u32 s76, s76, 139264
  v_lshlrev_b32 v8, 2, v1
  v_add_u32 v8, s76, v8
  s_waitcnt vmcnt(0)
  ds_read_b64_tr_b16 v[128:129], v80 offset:0
  ds_read_b64_tr_b16 v[130:131], v80 offset:2048
  ds_read_b64_tr_b16 v[132:133], v81 offset:0
  ds_read_b64_tr_b16 v[134:135], v81 offset:2048
  ds_read_b64_tr_b16 v[136:137], v82 offset:0
  ds_read_b64_tr_b16 v[138:139], v82 offset:2048
  ds_read_b64_tr_b16 v[140:141], v83 offset:0
  ds_read_b64_tr_b16 v[142:143], v83 offset:2048
  ds_read_b64_tr_b16 v[144:145], v80 offset:4096
  ds_read_b64_tr_b16 v[146:147], v80 offset:6144
  ds_read_b64_tr_b16 v[148:149], v81 offset:4096
  ds_read_b64_tr_b16 v[150:151], v81 offset:6144
  ds_read_b64_tr_b16 v[152:153], v82 offset:4096
  ds_read_b64_tr_b16 v[154:155], v82 offset:6144
  s_waitcnt lgkmcnt(12)
  v_mfma_f32_16x16x32_bf16 v[96:99], v[64:67], v[128:131], 0
  ds_read_b64_tr_b16 v[156:157], v83 offset:4096
  ds_read_b64_tr_b16 v[158:159], v83 offset:6144
  s_waitcnt lgkmcnt(12)
  v_mfma_f32_16x16x32_bf16 v[100:103], v[64:67], v[132:135], 0
  ds_read_b64_tr_b16 v[160:161], v80 offset:8192
  ds_read_b64_tr_b16 v[162:163], v80 offset:10240
  s_waitcnt lgkmcnt(12)
  v_mfma_f32_16x16x32_bf16 v[104:107], v[64:67], v[136:139], 0
  ds_read_b64_tr_b16 v[164:165], v81 offset:8192
  ds_read_b64_tr_b16 v[166:167], v81 offset:10240
  s_waitcnt lgkmcnt(12)
  v_mfma_f32_16x16x32_bf16 v[108:111], v[64:67], v[140:143], 0
  ds_read_b64_tr_b16 v[168:169], v82 offset:8192
  ds_read_b64_tr_b16 v[170:171], v82 offset:10240
  s_waitcnt lgkmcnt(12)
  v_mfma_f32_16x16x32_bf16 v[96:99], v[68:71], v[144:147], v[96:99]
  ds_read_b64_tr_b16 v[172:173], v83 offset:8192
  ds_read_b64_tr_b16 v[174:175], v83 offset:10240
  s_waitcnt lgkmcnt(12)
  v_mfma_f32_16x16x32_bf16 v[100:103], v[68:71], v[148:151], v[100:103]
  ds_read_b64_tr_b16 v[176:177], v80 offset:12288
  ds_read_b64_tr_b16 v[178:179], v80 offset:14336
  s_waitcnt lgkmcnt(12)
  v_mfma_f32_16x16x32_bf16 v[104:107], v[68:71], v[152:155], v[104:107]
  ds_read_b64_tr_b16 v[180:181], v81 offset:12288
  ds_read_b64_tr_b16 v[182:183], v81 offset:14336
  s_waitcnt lgkmcnt(12)
  v_mfma_f32_16x16x32_bf16 v[108:111], v[68:71], v[156:159], v[108:111]
  ds_read_b64_tr_b16 v[184:185], v82 offset:12288
  ds_read_b64_tr_b16 v[186:187], v82 offset:14336
  s_waitcnt lgkmcnt(12)
  v_mfma_f32_16x16x32_bf16 v[96:99], v[72:75], v[160:163], v[96:99]
  ds_read_b64_tr_b16 v[188:189], v83 offset:12288
  ds_read_b64_tr_b16 v[190:191], v83 offset:14336
  s_waitcnt lgkmcnt(12)
  v_mfma_f32_16x16x32_bf16 v[100:103], v[72:75], v[164:167], v[100:103]
  s_waitcnt lgkmcnt(10)
  v_mfma_f32_16x16x32_bf16 v[104:107], v[72:75], v[168:171], v[104:107]
  s_waitcnt lgkmcnt(8)
  v_mfma_f32_16x16x32_bf16 v[108:111], v[72:75], v[172:175], v[108:111]
  s_waitcnt lgkmcnt(6)
  v_mfma_f32_16x16x32_bf16 v[96:99], v[76:79], v[176:179], v[96:99]
  s_waitcnt lgkmcnt(4)
  v_mfma_f32_16x16x32_bf16 v[100:103], v[76:79], v[180:183], v[100:103]
  s_waitcnt lgkmcnt(2)
  v_mfma_f32_16x16x32_bf16 v[104:107], v[76:79], v[184:187], v[104:107]
  s_waitcnt lgkmcnt(0)
  v_mfma_f32_16x16x32_bf16 v[108:111], v[76:79], v[188:191], v[108:111]
  s_nop 3
  v_permlane16_swap_b32 v96, v100
  s_nop 2
  v_permlane16_swap_b32 v104, v108
  v_permlane16_swap_b32 v97, v101
  v_permlane16_swap_b32 v105, v109
  v_permlane32_swap_b32 v96, v104
  s_nop 0
  v_permlane32_swap_b32 v97, v105
  v_bfi_b32 v4, s73, v63, v96
  v_bfi_b32 v5, s73, v63, v97
  buffer_store_dword v4, v8, s[44:47], 0 offen sc1
  buffer_store_dword v5, v8, s[44:47], 0 offen offset:256 sc1
  s_branch L_no_h
L_ffn_b:
  s_sub_u32 s75, s2, 128
  s_lshl_b32 s76, s75, 14
  v_lshlrev_b32 v9, 4, v1
  v_add_u32 v9, s76, v9
  s_mov_b32 s77, 0
  buffer_load_dwordx4 v[192:195], v9, s[52:55], s77 offen nt
  s_mov_b32 s77, 1024
  buffer_load_dwordx4 v[196:199], v9, s[52:55], s77 offen nt
  s_mov_b32 s77, 2048
  buffer_load_dwordx4 v[200:203], v9, s[52:55], s77 offen nt
  s_mov_b32 s77, 3072
  buffer_load_dwordx4 v[204:207], v9, s[52:55], s77 offen nt
  s_mov_b32 s77, 4096
  buffer_load_dwordx4 v[208:211], v9, s[52:55], s77 offen nt
  s_mov_b32 s77, 5120
  buffer_load_dwordx4 v[212:215], v9, s[52:55], s77 offen nt
  s_mov_b32 s77, 6144
  buffer_load_dwordx4 v[216:219], v9, s[52:55], s77 offen nt
  s_mov_b32 s77, 7168
  buffer_load_dwordx4 v[220:223], v9, s[52:55], s77 offen nt
  s_mov_b32 s77, 8192
  buffer_load_dwordx4 v[224:227], v9, s[52:55], s77 offen nt
  s_mov_b32 s77, 9216
  buffer_load_dwordx4 v[228:231], v9, s[52:55], s77 offen nt
  s_mov_b32 s77, 10240
  buffer_load_dwordx4 v[232:235], v9, s[52:55], s77 offen nt
  s_mov_b32 s77, 11264
  buffer_load_dwordx4 v[236:239], v9, s[52:55], s77 offen nt
  s_mov_b32 s77, 12288
  buffer_load_dwordx4 v[240:243], v9, s[52:55], s77 offen nt
  s_mov_b32 s77, 13312
  buffer_load_dwordx4 v[244:247], v9, s[52:55], s77 offen nt
  s_mov_b32 s77, 14336
  buffer_load_dwordx4 v[248:251], v9, s[52:55], s77 offen nt
  s_mov_b32 s77, 15360
  buffer_load_dwordx4 v[252:255], v9, s[52:55], s77 offen nt
  v_and_b32 v3, 7, v1
  s_lshl_b32 s76, s75, 5
  v_lshl_add_u32 v4, v3, 2, s76
  buffer_load_dword v14, v4, s[48:51], 0 offen
  s_lshr_b32 s76, s75, 2
  s_lshl_b32 s76, s76, 11
  s_and_b32 s77, s75, 3
  s_lshl_b32 s77, s77, 6
  s_add_u32 s76, s76, s77
  s_add_u32 s76, s76, 139264
  v_lshrrev_b32 v4, 4, v1
  v_lshlrev_b32 v4, 9, v4
  v_bfe_u32 v5, v1, 3, 1
  v_lshl_add_u32 v4, v5, 8, v4
  v_lshl_add_u32 v8, v3, 3, v4
  v_add_u32 v8, s76, v8
  s_waitcnt vmcnt(0)
  v_perm_b32 v64, v196, v192, s80
  v_perm_b32 v65, v196, v192, s81
  v_perm_b32 v66, v197, v193, s80
  v_perm_b32 v67, v197, v193, s81
  v_perm_b32 v68, v198, v194, s80
  v_perm_b32 v69, v198, v194, s81
  v_perm_b32 v70, v199, v195, s80
  v_perm_b32 v71, v199, v195, s81
  v_perm_b32 v72, v204, v200, s80
  v_perm_b32 v73, v204, v200, s81
  v_perm_b32 v74, v205, v201, s80
  v_perm_b32 v75, v205, v201, s81
  v_perm_b32 v76, v206, v202, s80
  v_perm_b32 v77, v206, v202, s81
  v_perm_b32 v78, v207, v203, s80
  v_perm_b32 v79, v207, v203, s81
  v_perm_b32 v80, v212, v208, s80
  v_perm_b32 v81, v212, v208, s81
  v_perm_b32 v82, v213, v209, s80
  v_perm_b32 v83, v213, v209, s81
  v_perm_b32 v84, v214, v210, s80
  v_perm_b32 v85, v214, v210, s81
  v_perm_b32 v86, v215, v211, s80
  v_perm_b32 v87, v215, v211, s81
  v_perm_b32 v88, v220, v216, s80
  v_perm_b32 v89, v220, v216, s81
  v_perm_b32 v90, v221, v217, s80
  v_perm_b32 v91, v221, v217, s81
  v_perm_b32 v92, v222, v218, s80
  v_perm_b32 v93, v222, v218, s81
  v_perm_b32 v94, v223, v219, s80
  v_perm_b32 v95, v223, v219, s81
  v_perm_b32 v96, v228, v224, s80
  v_perm_b32 v97, v228, v224, s81
  v_perm_b32 v98, v229, v225, s80
  v_perm_b32 v99, v229, v225, s81
  v_perm_b32 v100, v230, v226, s80
  v_perm_b32 v101, v230, v226, s81
  v_perm_b32 v102, v231, v227, s80
  v_perm_b32 v103, v231, v227, s81
  v_perm_b32 v104, v236, v232, s80
  v_perm_b32 v105, v236, v232, s81
  v_perm_b32 v106, v237, v233, s80
  v_perm_b32 v107, v237, v233, s81
  v_perm_b32 v108, v238, v234, s80
  v_perm_b32 v109, v238, v234, s81
  v_perm_b32 v110, v239, v235, s80
  v_perm_b32 v111, v239, v235, s81
  v_perm_b32 v112, v244, v240, s80
  v_perm_b32 v113, v244, v240, s81
  v_perm_b32 v114, v245, v241, s80
  v_perm_b32 v115, v245, v241, s81
  v_perm_b32 v116, v246, v242, s80
  v_perm_b32 v117, v246, v242, s81
  v_perm_b32 v118, v247, v243, s80
  v_perm_b32 v119, v247, v243, s81
  v_perm_b32 v120, v252, v248, s80
  v_perm_b32 v121, v252, v248, s81
  v_perm_b32 v122, v253, v249, s80
  v_perm_b32 v123, v253, v249, s81
  v_perm_b32 v124, v254, v250, s80
  v_perm_b32 v125, v254, v250, s81
  v_perm_b32 v126, v255, v251, s80
  v_perm_b32 v127, v255, v251, s81
  s_mov_b32 s70, 30000
  s_nop 4
L_poll_h:
  buffer_load_dwordx2 v[4:5], v8, s[44:47], 0 offen sc1
  s_waitcnt vmcnt(0)
  v_xor_b32 v4, s74, v4
  v_xor_b32 v5, s74, v5
  v_or_b32 v32, v4, v5
  v_and_b32 v32, 1023, v32
  v_cmp_ne_u32 vcc, 0, v32
  s_cbranch_vccz L_poll_h_done
  s_sub_u32 s70, s70, 1
  s_cmp_eq_u32 s70, 0
  s_cbranch_scc1 L_poll_h_done
  s_sleep 32
  s_branch L_poll_h
L_poll_h_done:
  s_nop 4
  v_mov_b32 v6, v4
  v_mov_b32 v7, v5
  s_nop 0
  v_permlane16_swap_b32 v4, v6
  v_permlane16_swap_b32 v5, v7
  v_add_f32 v4, v4, v6
  v_add_f32 v5, v5, v7
  v_mov_b32 v6, v4
  v_mov_b32 v7, v5
  s_nop 0
  v_permlane32_swap_b32 v4, v6
  v_permlane32_swap_b32 v5, v7
  v_add_f32 v4, v4, v6
  v_add_f32 v5, v5, v7
  v_cvt_pk_bf16_f32 v10, v4, v5
  v_lshlrev_b32 v6, 16, v14
  v_and_b32 v7, 0xffff0000, v14
  v_lshlrev_b32 v4, 16, v10
  v_and_b32 v5, 0xffff0000, v10
  v_add_f32 v4, v4, v6
  v_add_f32 v5, v5, v7
  v_cvt_pk_bf16_f32 v10, v4, v5
  v_lshlrev_b32 v4, 16, v10
  v_and_b32 v5, 0xffff0000, v10
  s_mov_b32 s78, 0x3d372713
  s_mov_b32 s79, 0xc0135761
  v_mul_f32 v16, v4, v4
  v_fma_f32 v16, v16, s78, 1.0
  v_mul_f32 v16, v16, v4
  v_mul_f32 v16, s79, v16
  v_exp_f32 v16, v16
  s_nop 0
  v_add_f32 v16, 1.0, v16
  v_rcp_f32 v16, v16
  s_nop 0
  v_mul_f32 v4, v4, v16
  v_mul_f32 v18, v5, v5
  v_fma_f32 v18, v18, s78, 1.0
  v_mul_f32 v18, v18, v5
  v_mul_f32 v18, s79, v18
  v_exp_f32 v18, v18
  s_nop 0
  v_add_f32 v18, 1.0, v18
  v_rcp_f32 v18, v18
  s_nop 0
  v_mul_f32 v5, v5, v18
  v_cvt_pk_bf16_f32 v10, v4, v5
  s_nop 0
  v_readlane_b32 s82, v10, 0
  v_readlane_b32 s83, v10, 8
  s_nop 0
  v_dot2_f32_bf16 v16, s82, v64, 0
  v_dot2_f32_bf16 v17, s82, v65, 0
  v_dot2_f32_bf16 v18, s82, v66, 0
  v_dot2_f32_bf16 v19, s82, v67, 0
  v_dot2_f32_bf16 v20, s82, v68, 0
  v_dot2_f32_bf16 v21, s82, v69, 0
  v_dot2_f32_bf16 v22, s82, v70, 0
  v_dot2_f32_bf16 v23, s82, v71, 0
  v_dot2_f32_bf16 v24, s83, v64, 0
  v_dot2_f32_bf16 v25, s83, v65, 0
  v_dot2_f32_bf16 v26, s83, v66, 0
  v_dot2_f32_bf16 v27, s83, v67, 0
  v_dot2_f32_bf16 v28, s83, v68, 0
  v_dot2_f32_bf16 v29, s83, v69, 0
  v_dot2_f32_bf16 v30, s83, v70, 0
  v_dot2_f32_bf16 v31, s83, v71, 0
  v_readlane_b32 s82, v10, 1
  v_readlane_b32 s83, v10, 9
  s_nop 0
  v_dot2_f32_bf16 v16, s82, v72, v16
  v_dot2_f32_bf16 v17, s82, v73, v17
  v_dot2_f32_bf16 v18, s82, v74, v18
  v_dot2_f32_bf16 v19, s82, v75, v19
  v_dot2_f32_bf16 v20, s82, v76, v20
  v_dot2_f32_bf16 v21, s82, v77, v21
  v_dot2_f32_bf16 v22, s82, v78, v22
  v_dot2_f32_bf16 v23, s82, v79, v23
  v_dot2_f32_bf16 v24, s83, v72, v24
  v_dot2_f32_bf16 v25, s83, v73, v25
  v_dot2_f32_bf16 v26, s83, v74, v26
  v_dot2_f32_bf16 v27, s83, v75, v27
  v_dot2_f32_bf16 v28, s83, v76, v28
  v_dot2_f32_bf16 v29, s83, v77, v29
  v_dot2_f32_bf16 v30, s83, v78, v30
  v_dot2_f32_bf16 v31, s83, v79, v31
  v_readlane_b32 s82, v10, 2
  v_readlane_b32 s83, v10, 10
  s_nop 0
  v_dot2_f32_bf16 v16, s82, v80, v16
  v_dot2_f32_bf16 v17, s82, v81, v17
  v_dot2_f32_bf16 v18, s82, v82, v18
  v_dot2_f32_bf16 v19, s82, v83, v19
  v_dot2_f32_bf16 v20, s82, v84, v20
  v_dot2_f32_bf16 v21, s82, v85, v21
  v_dot2_f32_bf16 v22, s82, v86, v22
  v_dot2_f32_bf16 v23, s82, v87, v23
  v_dot2_f32_bf16 v24, s83, v80, v24
  v_dot2_f32_bf16 v25, s83, v81, v25
  v_dot2_f32_bf16 v26, s83, v82, v26
  v_dot2_f32_bf16 v27, s83, v83, v27
  v_dot2_f32_bf16 v28, s83, v84, v28
  v_dot2_f32_bf16 v29, s83, v85, v29
  v_dot2_f32_bf16 v30, s83, v86, v30
  v_dot2_f32_bf16 v31, s83, v87, v31
  v_readlane_b32 s82, v10, 3
  v_readlane_b32 s83, v10, 11
  s_nop 0
  v_dot2_f32_bf16 v16, s82, v88, v16
  v_dot2_f32_bf16 v17, s82, v89, v17
  v_dot2_f32_bf16 v18, s82, v90, v18
  v_dot2_f32_bf16 v19, s82, v91, v19
  v_dot2_f32_bf16 v20, s82, v92, v20
  v_dot2_f32_bf16 v21, s82, v93, v21
  v_dot2_f32_bf16 v22, s82, v94, v22
  v_dot2_f32_bf16 v23, s82, v95, v23
  v_dot2_f32_bf16 v24, s83, v88, v24
  v_dot2_f32_bf16 v25, s83, v89, v25
  v_dot2_f32_bf16 v26, s83, v90, v26
  v_dot2_f32_bf16 v27, s83, v91, v27
  v_dot2_f32_bf16 v28, s83, v92, v28
  v_dot2_f32_bf16 v29, s83, v93, v29
  v_dot2_f32_bf16 v30, s83, v94, v30
  v_dot2_f32_bf16 v31, s83, v95, v31
  v_readlane_b32 s82, v10, 4
  v_readlane_b32 s83, v10, 12
  s_nop 0
  v_dot2_f32_bf16 v16, s82, v96, v16
  v_dot2_f32_bf16 v17, s82, v97, v17
  v_dot2_f32_bf16 v18, s82, v98, v18
  v_dot2_f32_bf16 v19, s82, v99, v19
  v_dot2_f32_bf16 v20, s82, v100, v20
  v_dot2_f32_bf16 v21, s82, v101, v21
  v_dot2_f32_bf16 v22, s82, v102, v22
  v_dot2_f32_bf16 v23, s82, v103, v23
  v_dot2_f32_bf16 v24, s83, v96, v24
  v_dot2_f32_bf16 v25, s83, v97, v25
  v_dot2_f32_bf16 v26, s83, v98, v26
  v_dot2_f32_bf16 v27, s83, v99, v27
  v_dot2_f32_bf16 v28, s83, v100, v28
  v_dot2_f32_bf16 v29, s83, v101, v29
  v_dot2_f32_bf16 v30, s83, v102, v30
  v_dot2_f32_bf16 v31, s83, v103, v31
  v_readlane_b32 s82, v10, 5
  v_readlane_b32 s83, v10, 13
  s_nop 0
  v_dot2_f32_bf16 v16, s82, v104, v16
  v_dot2_f32_bf16 v17, s82, v105, v17
  v_dot2_f32_bf16 v18, s82, v106, v18
  v_dot2_f32_bf16 v19, s82, v107, v19
  v_dot2_f32_bf16 v20, s82, v108, v20
  v_dot2_f32_bf16 v21, s82, v109, v21
  v_dot2_f32_bf16 v22, s82, v110, v22
  v_dot2_f32_bf16 v23, s82, v111, v23
  v_dot2_f32_bf16 v24, s83, v104, v24
  v_dot2_f32_bf16 v25, s83, v105, v25
  v_dot2_f32_bf16 v26, s83, v106, v26
  v_dot2_f32_bf16 v27, s83, v107, v27
  v_dot2_f32_bf16 v28, s83, v108, v28
  v_dot2_f32_bf16 v29, s83, v109, v29
  v_dot2_f32_bf16 v30, s83, v110, v30
  v_dot2_f32_bf16 v31, s83, v111, v31
  v_readlane_b32 s82, v10, 6
  v_readlane_b32 s83, v10, 14
  s_nop 0
  v_dot2_f32_bf16 v16, s82, v112, v16
  v_dot2_f32_bf16 v17, s82, v113, v17
  v_dot2_f32_bf16 v18, s82, v114, v18
  v_dot2_f32_bf16 v19, s82, v115, v19
  v_dot2_f32_bf16 v20, s82, v116, v20
  v_dot2_f32_bf16 v21, s82, v117, v21
  v_dot2_f32_bf16 v22, s82, v118, v22
  v_dot2_f32_bf16 v23, s82, v119, v23
  v_dot2_f32_bf16 v24, s83, v112, v24
  v_dot2_f32_bf16 v25, s83, v113, v25
  v_dot2_f32_bf16 v26, s83, v114, v26
  v_dot2_f32_bf16 v27, s83, v115, v27
  v_dot2_f32_bf16 v28, s83, v116, v28
  v_dot2_f32_bf16 v29, s83, v117, v29
  v_dot2_f32_bf16 v30, s83, v118, v30
  v_dot2_f32_bf16 v31, s83, v119, v31
  v_readlane_b32 s82, v10, 7
  v_readlane_b32 s83, v10, 15
  s_nop 0
  v_dot2_f32_bf16 v16, s82, v120, v16
  v_dot2_f32_bf16 v17, s82, v121, v17
  v_dot2_f32_bf16 v18, s82, v122, v18
  v_dot2_f32_bf16 v19, s82, v123, v19
  v_dot2_f32_bf16 v20, s82, v124, v20
  v_dot2_f32_bf16 v21, s82, v125, v21
  v_dot2_f32_bf16 v22, s82, v126, v22
  v_dot2_f32_bf16 v23, s82, v127, v23
  v_dot2_f32_bf16 v24, s83, v120, v24
  v_dot2_f32_bf16 v25, s83, v121, v25
  v_dot2_f32_bf16 v26, s83, v122, v26
  v_dot2_f32_bf16 v27, s83, v123, v27
  v_dot2_f32_bf16 v28, s83, v124, v28
  v_dot2_f32_bf16 v29, s83, v125, v29
  v_dot2_f32_bf16 v30, s83, v126, v30
  v_dot2_f32_bf16 v31, s83, v127, v31
  v_lshlrev_b32 v2, 5, v1
  v_add_u32 v2, 131072, v2
  ds_write_b128 v2, v[16:19] offset:0
  ds_write_b128 v2, v[20:23] offset:16
  ds_write_b128 v2, v[24:27] offset:2048
  ds_write_b128 v2, v[28:31] offset:2064
  v_lshlrev_b32 v2, 4, v1
  s_lshl_b32 s76, s75, 12
  s_add_u32 s76, s76, 1310720
  v_add_u32 v3, s76, v2
  v_add_u32 v2, 131072, v2
  s_waitcnt lgkmcnt(0)
  ds_read_b128 v[32:35], v2 offset:0
  ds_read_b128 v[36:39], v2 offset:1024
  ds_read_b128 v[40:43], v2 offset:2048
  ds_read_b128 v[44:47], v2 offset:3072
  s_waitcnt lgkmcnt(0)
  v_bfi_b32 v32, s73, v63, v32
  v_bfi_b32 v33, s73, v63, v33
  v_bfi_b32 v34, s73, v63, v34
  v_bfi_b32 v35, s73, v63, v35
  buffer_store_dwordx4 v[32:35], v3, s[44:47], 0 offen offset:0 sc1
  v_bfi_b32 v36, s73, v63, v36
  v_bfi_b32 v37, s73, v63, v37
  v_bfi_b32 v38, s73, v63, v38
  v_bfi_b32 v39, s73, v63, v39
  buffer_store_dwordx4 v[36:39], v3, s[44:47], 0 offen offset:1024 sc1
  v_bfi_b32 v40, s73, v63, v40
  v_bfi_b32 v41, s73, v63, v41
  v_bfi_b32 v42, s73, v63, v42
  v_bfi_b32 v43, s73, v63, v43
  buffer_store_dwordx4 v[40:43], v3, s[44:47], 0 offen offset:2048 sc1
  v_bfi_b32 v44, s73, v63, v44
  v_bfi_b32 v45, s73, v63, v45
  v_bfi_b32 v46, s73, v63, v46
  v_bfi_b32 v47, s73, v63, v47
  buffer_store_dwordx4 v[44:47], v3, s[44:47], 0 offen offset:3072 sc1
L_no_h:
  s_nop 4
  v_mov_b32 v40, 151096
  s_mov_b32 s70, 240000
L_ckw0:
  ds_read_b64 v[42:43], v40
  s_waitcnt lgkmcnt(0)
  v_readfirstlane_b32 s76, v42
  v_readfirstlane_b32 s84, v43
  s_cmp_ge_u32 s76, 1
  s_cbranch_scc1 L_cko0
  s_sub_u32 s70, s70, 1
  s_cmp_lg_u32 s70, 0
  s_cbranch_scc0 L_cko0
  s_sleep 6
  s_branch L_ckw0
L_cko0:
  s_cmp_gt_u32 s76, 1
  s_cbranch_scc1 L_ckskip0
  s_sub_u32 s76, s68, s67
  s_and_b32 s76, s76, 15
  s_lshl_b32 s76, s76, 7
  s_add_u32 s76, s76, 212992
  s_lshl_b32 s77, s67, 3
  s_add_u32 s77, s77, s76
  v_mov_b32 v44, s84
  v_mov_b32 v45, s66
  v_mov_b32 v46, s77
  s_mov_b64 exec, 1
  buffer_store_dwordx2 v[44:45], v46, s[44:47], 0 offen sc1
  s_mov_b64 exec, -1
  v_and_b32 v46, 15, v1
  v_lshl_add_u32 v46, v46, 3, s76
  s_sleep 48
  buffer_load_dwordx2 v[44:45], v46, s[44:47], 0 offen sc1
  s_waitcnt vmcnt(0)
  s_memrealtime s[86:87]
  v_cmp_eq_u32 vcc, s66, v45
  s_waitcnt lgkmcnt(0)
  v_mov_b32 v47, s86
  v_cndmask_b32 v44, v47, v44, vcc
  v_subrev_u32 v44, s84, v44
  v_cvt_f32_i32 v44, v44
  s_nop 1
  v_add_f32_dpp v44, v44, v44 row_ror:8 row_mask:0xf bank_mask:0xf
  s_nop 1
  v_add_f32_dpp v44, v44, v44 row_ror:4 row_mask:0xf bank_mask:0xf
  s_nop 1
  v_add_f32_dpp v44, v44, v44 row_ror:2 row_mask:0xf bank_mask:0xf
  s_nop 1
  v_add_f32_dpp v44, v44, v44 row_ror:1 row_mask:0xf bank_mask:0xf
  s_mov_b32 s77, 0xc4200000
  s_mov_b32 s78, 0x44200000
  v_mov_b32 v46, 1
  v_cmp_gt_f32 vcc, s77, v44
  s_nop 1
  v_cndmask_b32 v46, v46, 2, vcc
  v_cmp_lt_f32 vcc, s78, v44
  s_nop 1
  v_cndmask_b32 v46, v46, 0, vcc
  v_mov_b32 v47, 151088
  ds_write_b32 v47, v46
L_ckskip0:
  s_and_b32 s76, s2, 127
  s_cmp_lt_u32 s76, 112
  s_cbranch_scc1 L_no_red
  s_sub_u32 s75, s76, 112
  s_lshr_b32 s77, s2, 7
  s_lshl_b32 s76, s77, 11
  s_lshl_b32 s78, s75, 7
  s_add_u32 s76, s76, s78
  s_add_u32 s79, s76, 1769472
  s_add_u32 s76, s76, 1310720
  v_lshrrev_b32 v8, 3, v1
  v_lshlrev_b32 v8, 12, v8
  v_and_b32 v9, 7, v1
  v_lshl_add_u32 v8, v9, 4, v8
  v_add_u32 v8, s76, v8
  v_lshlrev_b32 v10, 4, v9
  v_add_u32 v10, s79, v10
  s_lshl_b32 s78, s75, 6
  v_lshl_add_u32 v9, v9, 3, s78
  buffer_load_dwordx2 v[12:13], v9, s[56:59], 0 offen
  s_mov_b32 s70, 30000
  s_mov_b64 s[82:83], exec
L_poll_r:
  s_mov_b32 s77, 0
  buffer_load_dwordx4 v[64:67], v8, s[44:47], s77 offen sc1
  s_mov_b32 s77, 32768
  buffer_load_dwordx4 v[68:71], v8, s[44:47], s77 offen sc1
  s_mov_b32 s77, 65536
  buffer_load_dwordx4 v[72:75], v8, s[44:47], s77 offen sc1
  s_mov_b32 s77, 98304
  buffer_load_dwordx4 v[76:79], v8, s[44:47], s77 offen sc1
  s_mov_b32 s77, 131072
  buffer_load_dwordx4 v[80:83], v8, s[44:47], s77 offen sc1
  s_mov_b32 s77, 163840
  buffer_load_dwordx4 v[84:87], v8, s[44:47], s77 offen sc1
  s_mov_b32 s77, 196608
  buffer_load_dwordx4 v[88:91], v8, s[44:47], s77 offen sc1
  s_mov_b32 s77, 229376
  buffer_load_dwordx4 v[92:95], v8, s[44:47], s77 offen sc1
  s_mov_b32 s77, 262144
  buffer_load_dwordx4 v[96:99], v8, s[44:47], s77 offen sc1
  s_mov_b32 s77, 294912
  buffer_load_dwordx4 v[100:103], v8, s[44:47], s77 offen sc1
  s_mov_b32 s77, 327680
  buffer_load_dwordx4 v[104:107], v8, s[44:47], s77 offen sc1
  s_mov_b32 s77, 360448
  buffer_load_dwordx4 v[108:111], v8, s[44:47], s77 offen sc1
  s_mov_b32 s77, 393216
  buffer_load_dwordx4 v[112:115], v8, s[44:47], s77 offen sc1
  s_mov_b32 s77, 425984
  buffer_load_dwordx4 v[116:119], v8, s[44:47], s77 offen sc1
  s_waitcnt vmcnt(0)
  v_xor_b32 v64, s74, v64
  v_xor_b32 v65, s74, v65
  v_xor_b32 v66, s74, v66
  v_xor_b32 v67, s74, v67
  v_xor_b32 v68, s74, v68
  v_xor_b32 v69, s74, v69
  v_xor_b32 v70, s74, v70
  v_xor_b32 v71, s74, v71
  v_xor_b32 v72, s74, v72
  v_xor_b32 v73, s74, v73
  v_xor_b32 v74, s74, v74
  v_xor_b32 v75, s74, v75
  v_xor_b32 v76, s74, v76
  v_xor_b32 v77, s74, v77
  v_xor_b32 v78, s74, v78
  v_xor_b32 v79, s74, v79
  v_xor_b32 v80, s74, v80
  v_xor_b32 v81, s74, v81
  v_xor_b32 v82, s74, v82
  v_xor_b32 v83, s74, v83
  v_xor_b32 v84, s74, v84
  v_xor_b32 v85, s74, v85
  v_xor_b32 v86, s74, v86
  v_xor_b32 v87, s74, v87
  v_xor_b32 v88, s74, v88
  v_xor_b32 v89, s74, v89
  v_xor_b32 v90, s74, v90
  v_xor_b32 v91, s74, v91
  v_xor_b32 v92, s74, v92
  v_xor_b32 v93, s74, v93
  v_xor_b32 v94, s74, v94
  v_xor_b32 v95, s74, v95
  v_xor_b32 v96, s74, v96
  v_xor_b32 v97, s74, v97
  v_xor_b32 v98, s74, v98
  v_xor_b32 v99, s74, v99
  v_xor_b32 v100, s74, v100
  v_xor_b32 v101, s74, v101
  v_xor_b32 v102, s74, v102
  v_xor_b32 v103, s74, v103
  v_xor_b32 v104, s74, v104
  v_xor_b32 v105, s74, v105
  v_xor_b32 v106, s74, v106
  v_xor_b32 v107, s74, v107
  v_xor_b32 v108, s74, v108
  v_xor_b32 v109, s74, v109
  v_xor_b32 v110, s74, v110
  v_xor_b32 v111, s74, v111
  v_xor_b32 v112, s74, v112
  v_xor_b32 v113, s74, v113
  v_xor_b32 v114, s74, v114
  v_xor_b32 v115, s74, v115
  v_xor_b32 v116, s74, v116
  v_xor_b32 v117, s74, v117
  v_xor_b32 v118, s74, v118
  v_xor_b32 v119, s74, v119
  v_or3_b32 v32, v64, v65, v66
  v_or3_b32 v32, v32, v67, v68
  v_or3_b32 v32, v32, v69, v70
  v_or3_b32 v32, v32, v71, v72
  v_or3_b32 v32, v32, v73, v74
  v_or3_b32 v32, v32, v75, v76
  v_or3_b32 v32, v32, v77, v78
  v_or3_b32 v32, v32, v79, v80
  v_or3_b32 v32, v32, v81, v82
  v_or3_b32 v32, v32, v83, v84
  v_or3_b32 v32, v32, v85, v86
  v_or3_b32 v32, v32, v87, v88
  v_or3_b32 v32, v32, v89, v90
  v_or3_b32 v32, v32, v91, v92
  v_or3_b32 v32, v32, v93, v94
  v_or3_b32 v32, v32, v95, v96
  v_or3_b32 v32, v32, v97, v98
  v_or3_b32 v32, v32, v99, v100
  v_or3_b32 v32, v32, v101, v102
  v_or3_b32 v32, v32, v103, v104
  v_or3_b32 v32, v32, v105, v106
  v_or3_b32 v32, v32, v107, v108
  v_or3_b32 v32, v32, v109, v110
  v_or3_b32 v32, v32, v111, v112
  v_or3_b32 v32, v32, v113, v114
  v_or3_b32 v32, v32, v115, v116
  v_or3_b32 v32, v32, v117, v118
  v_or_b32 v32, v32, v119
  v_and_b32 v32, 1023, v32
  v_cmp_ne_u32 vcc, 0, v32
  s_nop 0
  s_and_b64 exec, exec, vcc
  s_cbranch_scc0 L_poll_r_done
  s_sub_u32 s70, s70, 1
  s_cmp_eq_u32 s70, 0
  s_cbranch_scc1 L_poll_r_done
  s_sleep 32
  s_branch L_poll_r
L_poll_r_done:
  s_mov_b64 exec, s[82:83]
  s_nop 1
  v_pk_add_f32 v[64:65], v[64:65], v[68:69]
  v_pk_add_f32 v[66:67], v[66:67], v[70:71]
  v_pk_add_f32 v[64:65], v[64:65], v[72:73]
  v_pk_add_f32 v[66:67], v[66:67], v[74:75]
  v_pk_add_f32 v[64:65], v[64:65], v[76:77]
  v_pk_add_f32 v[66:67], v[66:67], v[78:79]
  v_pk_add_f32 v[64:65], v[64:65], v[80:81]
  v_pk_add_f32 v[66:67], v[66:67], v[82:83]
  v_pk_add_f32 v[64:65], v[64:65], v[84:85]
  v_pk_add_f32 v[66:67], v[66:67], v[86:87]
  v_pk_add_f32 v[64:65], v[64:65], v[88:89]
  v_pk_add_f32 v[66:67], v[66:67], v[90:91]
  v_pk_add_f32 v[64:65], v[64:65], v[92:93]
  v_pk_add_f32 v[66:67], v[66:67], v[94:95]
  v_pk_add_f32 v[64:65], v[64:65], v[96:97]
  v_pk_add_f32 v[66:67], v[66:67], v[98:99]
  v_pk_add_f32 v[64:65], v[64:65], v[100:101]
  v_pk_add_f32 v[66:67], v[66:67], v[102:103]
  v_pk_add_f32 v[64:65], v[64:65], v[104:105]
  v_pk_add_f32 v[66:67], v[66:67], v[106:107]
  v_pk_add_f32 v[64:65], v[64:65], v[108:109]
  v_pk_add_f32 v[66:67], v[66:67], v[110:111]
  v_pk_add_f32 v[64:65], v[64:65], v[112:113]
  v_pk_add_f32 v[66:67], v[66:67], v[114:115]
  v_pk_add_f32 v[64:65], v[64:65], v[116:117]
  v_pk_add_f32 v[66:67], v[66:67], v[118:119]
  s_nop 0
  v_add_f32_dpp v64, v64, v64 row_ror:8 row_mask:0xf bank_mask:0xf
  v_add_f32_dpp v65, v65, v65 row_ror:8 row_mask:0xf bank_mask:0xf
  v_add_f32_dpp v66, v66, v66 row_ror:8 row_mask:0xf bank_mask:0xf
  v_add_f32_dpp v67, v67, v67 row_ror:8 row_mask:0xf bank_mask:0xf
  v_mov_b32 v16, v64
  v_mov_b32 v17, v65
  v_mov_b32 v18, v66
  v_mov_b32 v19, v67
  v_permlane16_swap_b32 v64, v16
  v_permlane16_swap_b32 v65, v17
  v_permlane16_swap_b32 v66, v18
  v_permlane16_swap_b32 v67, v19
  v_add_f32 v64, v64, v16
  v_add_f32 v65, v65, v17
  v_add_f32 v66, v66, v18
  v_add_f32 v67, v67, v19
  v_mov_b32 v16, v64
  v_mov_b32 v17, v65
  v_mov_b32 v18, v66
  v_mov_b32 v19, v67
  v_permlane32_swap_b32 v64, v16
  v_permlane32_swap_b32 v65, v17
  v_permlane32_swap_b32 v66, v18
  v_permlane32_swap_b32 v67, v19
  v_add_f32 v64, v64, v16
  v_add_f32 v65, v65, v17
  v_add_f32 v66, v66, v18
  v_add_f32 v67, v67, v19
  v_cvt_pk_bf16_f32 v16, v64, v65
  v_cvt_pk_bf16_f32 v17, v66, v67
  v_lshlrev_b32 v20, 16, v16
  v_and_b32 v21, 0xffff0000, v16
  v_lshlrev_b32 v24, 16, v12
  v_and_b32 v25, 0xffff0000, v12
  v_lshlrev_b32 v22, 16, v17
  v_and_b32 v23, 0xffff0000, v17
  v_lshlrev_b32 v26, 16, v13
  v_and_b32 v27, 0xffff0000, v13
  v_add_f32 v20, v20, v24
  v_add_f32 v21, v21, v25
  v_add_f32 v22, v22, v26
  v_add_f32 v23, v23, v27
  v_cvt_pk_bf16_f32 v16, v20, v21
  v_cvt_pk_bf16_f32 v17, v22, v23
  v_lshlrev_b32 v20, 16, v16
  v_and_b32 v21, 0xffff0000, v16
  v_lshlrev_b32 v22, 16, v17
  v_and_b32 v23, 0xffff0000, v17
  v_mul_f32 v24, 0xbfb8aa3b, v20
  v_mul_f32 v25, 0xbfb8aa3b, v21
  v_mul_f32 v26, 0xbfb8aa3b, v22
  v_mul_f32 v27, 0xbfb8aa3b, v23
  v_exp_f32 v24, v24
  v_exp_f32 v25, v25
  v_exp_f32 v26, v26
  v_exp_f32 v27, v27
  v_add_f32 v24, 1.0, v24
  v_add_f32 v25, 1.0, v25
  v_add_f32 v26, 1.0, v26
  v_add_f32 v27, 1.0, v27
  v_rcp_f32 v24, v24
  v_rcp_f32 v25, v25
  v_rcp_f32 v26, v26
  v_rcp_f32 v27, v27
  v_mul_f32 v20, v20, v24
  v_mul_f32 v21, v21, v25
  v_mul_f32 v22, v22, v26
  v_mul_f32 v23, v23, v27
  v_cvt_pk_bf16_f32 v16, v20, v21
  v_cvt_pk_bf16_f32 v17, v22, v23
  v_lshlrev_b32 v20, 16, v16
  v_and_b32 v21, 0xffff0000, v16
  v_lshlrev_b32 v22, 16, v17
  v_and_b32 v23, 0xffff0000, v17
  v_bfi_b32 v20, s73, v63, v20
  v_bfi_b32 v21, s73, v63, v21
  v_bfi_b32 v22, s73, v63, v22
  v_bfi_b32 v23, s73, v63, v23
  s_mov_b64 exec, 0xff
  buffer_store_dwordx4 v[20:23], v10, s[44:47], 0 offen sc1
  s_mov_b64 exec, -1
L_no_red:
  s_nop 4
  v_mov_b32 v40, 151096
  s_mov_b32 s70, 240000
L_ckw1:
  ds_read_b64 v[42:43], v40
  s_waitcnt lgkmcnt(0)
  v_readfirstlane_b32 s76, v42
  v_readfirstlane_b32 s84, v43
  s_cmp_ge_u32 s76, 2
  s_cbranch_scc1 L_cko1
  s_sub_u32 s70, s70, 1
  s_cmp_lg_u32 s70, 0
  s_cbranch_scc0 L_cko1
  s_sleep 6
  s_branch L_ckw1
L_cko1:
  s_cmp_gt_u32 s76, 2
  s_cbranch_scc1 L_ckskip1
  s_sub_u32 s76, s68, s67
  s_and_b32 s76, s76, 15
  s_lshl_b32 s76, s76, 7
  s_add_u32 s76, s76, 215040
  s_lshl_b32 s77, s67, 3
  s_add_u32 s77, s77, s76
  v_mov_b32 v44, s84
  v_mov_b32 v45, s66
  v_mov_b32 v46, s77
  s_mov_b64 exec, 1
  buffer_store_dwordx2 v[44:45], v46, s[44:47], 0 offen sc1
  s_mov_b64 exec, -1
  v_and_b32 v46, 15, v1
  v_lshl_add_u32 v46, v46, 3, s76
  s_sleep 48
  buffer_load_dwordx2 v[44:45], v46, s[44:47], 0 offen sc1
  s_waitcnt vmcnt(0)
  s_memrealtime s[86:87]
  v_cmp_eq_u32 vcc, s66, v45
  s_waitcnt lgkmcnt(0)
  v_mov_b32 v47, s86
  v_cndmask_b32 v44, v47, v44, vcc
  v_subrev_u32 v44, s84, v44
  v_cvt_f32_i32 v44, v44
  s_nop 1
  v_add_f32_dpp v44, v44, v44 row_ror:8 row_mask:0xf bank_mask:0xf
  s_nop 1
  v_add_f32_dpp v44, v44, v44 row_ror:4 row_mask:0xf bank_mask:0xf
  s_nop 1
  v_add_f32_dpp v44, v44, v44 row_ror:2 row_mask:0xf bank_mask:0xf
  s_nop 1
  v_add_f32_dpp v44, v44, v44 row_ror:1 row_mask:0xf bank_mask:0xf
  s_mov_b32 s77, 0xc4200000
  s_mov_b32 s78, 0x44200000
  v_mov_b32 v46, 1
  v_cmp_gt_f32 vcc, s77, v44
  s_nop 1
  v_cndmask_b32 v46, v46, 2, vcc
  v_cmp_lt_f32 vcc, s78, v44
  s_nop 1
  v_cndmask_b32 v46, v46, 0, vcc
  v_mov_b32 v47, 151088
  ds_write_b32 v47, v46
L_ckskip1:
  v_mov_b32 v40, 151096
  s_mov_b32 s70, 240000
L_ckw2:
  ds_read_b64 v[42:43], v40
  s_waitcnt lgkmcnt(0)
  v_readfirstlane_b32 s76, v42
  v_readfirstlane_b32 s84, v43
  s_cmp_ge_u32 s76, 3
  s_cbranch_scc1 L_cko2
  s_sub_u32 s70, s70, 1
  s_cmp_lg_u32 s70, 0
  s_cbranch_scc0 L_cko2
  s_sleep 6
  s_branch L_ckw2
L_cko2:
  s_cmp_gt_u32 s76, 3
  s_cbranch_scc1 L_ckskip2
  s_sub_u32 s76, s68, s67
  s_and_b32 s76, s76, 15
  s_lshl_b32 s76, s76, 7
  s_add_u32 s76, s76, 217088
  s_lshl_b32 s77, s67, 3
  s_add_u32 s77, s77, s76
  v_mov_b32 v44, s84
  v_mov_b32 v45, s66
  v_mov_b32 v46, s77
  s_mov_b64 exec, 1
  buffer_store_dwordx2 v[44:45], v46, s[44:47], 0 offen sc1
  s_mov_b64 exec, -1
  v_and_b32 v46, 15, v1
  v_lshl_add_u32 v46, v46, 3, s76
  s_sleep 48
  buffer_load_dwordx2 v[44:45], v46, s[44:47], 0 offen sc1
  s_waitcnt vmcnt(0)
  s_memrealtime s[86:87]
  v_cmp_eq_u32 vcc, s66, v45
  s_waitcnt lgkmcnt(0)
  v_mov_b32 v47, s86
  v_cndmask_b32 v44, v47, v44, vcc
  v_subrev_u32 v44, s84, v44
  v_cvt_f32_i32 v44, v44
  s_nop 1
  v_add_f32_dpp v44, v44, v44 row_ror:8 row_mask:0xf bank_mask:0xf
  s_nop 1
  v_add_f32_dpp v44, v44, v44 row_ror:4 row_mask:0xf bank_mask:0xf
  s_nop 1
  v_add_f32_dpp v44, v44, v44 row_ror:2 row_mask:0xf bank_mask:0xf
  s_nop 1
  v_add_f32_dpp v44, v44, v44 row_ror:1 row_mask:0xf bank_mask:0xf
  s_mov_b32 s77, 0xc4200000
  s_mov_b32 s78, 0x44200000
  v_mov_b32 v46, 1
  v_cmp_gt_f32 vcc, s77, v44
  s_nop 1
  v_cndmask_b32 v46, v46, 2, vcc
  v_cmp_lt_f32 vcc, s78, v44
  s_nop 1
  v_cndmask_b32 v46, v46, 0, vcc
  v_mov_b32 v47, 151088
  ds_write_b32 v47, v46
L_ckskip2:
  v_mov_b32 v3, 151040
  s_mov_b32 s70, 240000
L_cntwait:
  ds_read_b32 v4, v3
  s_waitcnt lgkmcnt(0)
  v_readfirstlane_b32 s76, v4
  s_nop 0
  s_cmp_ge_u32 s76, 4
  s_cbranch_scc1 L_cntok
  s_sub_u32 s70, s70, 1
  s_cmp_lg_u32 s70, 0
  s_cbranch_scc0 L_cntok
  s_sleep 8
  s_branch L_cntwait
L_cntok:
  v_and_b32 v3, 15, v1
  v_lshlrev_b32 v3, 3, v3
  v_add_u32 v3, 150656, v3
  ds_read_b64 v[4:5], v3
  s_waitcnt lgkmcnt(0)
  v_mov_b32 v6, v4
  s_nop 1
  v_max_f32_dpp v6, v6, v6 row_ror:4 row_mask:0xf bank_mask:0xf
  s_nop 1
  v_max_f32_dpp v6, v6, v6 row_ror:8 row_mask:0xf bank_mask:0xf
  v_sub_f32 v7, v4, v6
  v_exp_f32 v7, v7
  s_nop 0
  v_mul_f32 v7, v7, v5
  s_nop 1
  v_add_f32_dpp v7, v7, v7 row_ror:4 row_mask:0xf bank_mask:0xf
  s_nop 1
  v_add_f32_dpp v7, v7, v7 row_ror:8 row_mask:0xf bank_mask:0xf
  s_lshl_b32 s76, s67, 10
  s_add_u32 s76, s76, 196608
  s_lshl_b32 s77, s68, 6
  s_add_u32 s77, s77, s76
  v_lshlrev_b32 v8, 4, v1
  v_add_u32 v9, s77, v8
  v_add_u32 v8, s76, v8
  v_mov_b32 v12, v6
  v_mov_b32 v13, s66
  v_mov_b32 v14, v7
  v_mov_b32 v15, s66
  s_mov_b64 exec, 15
  buffer_store_dwordx4 v[12:15], v9, s[44:47], 0 offen sc1
  s_mov_b64 exec, -1
  s_mov_b32 s70, 30000
  s_mov_b64 s[82:83], exec
L_poll_s:
  buffer_load_dwordx4 v[16:19], v8, s[44:47], 0 offen sc1
  s_waitcnt vmcnt(0)
  v_xor_b32 v32, s66, v17
  v_xor_b32 v33, s66, v19
  v_or_b32 v32, v32, v33
  v_cmp_ne_u32 vcc, 0, v32
  s_nop 0
  s_and_b64 exec, exec, vcc
  s_cbranch_scc0 L_poll_s_done
  s_sub_u32 s70, s70, 1
  s_cmp_eq_u32 s70, 0
  s_cbranch_scc1 L_poll_s_done
  s_sleep 32
  s_branch L_poll_s
L_poll_s_done:
  s_mov_b64 exec, s[82:83]
  s_nop 1
  v_mov_b32 v10, v16
  s_nop 1
  v_max_f32_dpp v10, v10, v10 row_ror:4 row_mask:0xf bank_mask:0xf
  s_nop 1
  v_max_f32_dpp v10, v10, v10 row_ror:8 row_mask:0xf bank_mask:0xf
  v_mov_b32 v11, v10
  s_nop 1
  v_permlane16_swap_b32 v10, v11
  v_max_f32 v10, v10, v11
  v_mov_b32 v11, v10
  s_nop 1
  v_permlane32_swap_b32 v10, v11
  v_max_f32 v10, v10, v11
  v_sub_f32 v11, v16, v10
  v_exp_f32 v11, v11
  s_nop 0
  v_mul_f32 v11, v11, v18
  s_nop 1
  v_add_f32_dpp v11, v11, v11 row_ror:4 row_mask:0xf bank_mask:0xf
  s_nop 1
  v_add_f32_dpp v11, v11, v11 row_ror:8 row_mask:0xf bank_mask:0xf
  v_mov_b32 v12, v11
  s_nop 1
  v_permlane16_swap_b32 v11, v12
  v_add_f32 v11, v11, v12
  v_mov_b32 v12, v11
  s_nop 1
  v_permlane32_swap_b32 v11, v12
  v_add_f32 v11, v11, v12
  v_rcp_f32 v12, v11
  v_sub_f32 v13, v4, v10
  v_exp_f32 v13, v13
  v_fma_f32 v14, -v11, v12, 1.0
  v_fma_f32 v12, v14, v12, v12
  v_mul_f32 v13, v13, v12
  v_lshlrev_b32 v3, 2, v1
  v_add_u32 v3, 150784, v3
  s_mov_b64 exec, 0xffff
  ds_write_b32 v3, v13
  s_mov_b64 exec, -1
  v_lshlrev_b32 v9, 2, v1
  s_lshl_b32 s76, s69, 1
  v_add_u32 v9, s76, v9
  s_lshl_b32 s76, s71, 10
  v_add_u32 v21, s76, v9
  buffer_load_dword v22, v21, s[32:35], 0 offen
  buffer_load_dword v23, v21, s[60:63], 0 offen
  s_lshl_b32 s76, s71, 11
  s_lshl_b32 s77, s69, 2
  s_add_u32 s76, s76, s77
  s_add_u32 s76, s76, 1769472
  v_mov_b32 v8, s76
  s_mov_b32 s70, 30000
  s_nop 4
L_poll_g:
  buffer_load_dwordx4 v[24:27], v8, s[44:47], 0 offen sc1
  s_waitcnt vmcnt(0)
  v_xor_b32 v24, s74, v24
  v_xor_b32 v25, s74, v25
  v_xor_b32 v26, s74, v26
  v_xor_b32 v27, s74, v27
  v_or3_b32 v32, v24, v25, v26
  v_or_b32 v32, v32, v27
  v_and_b32 v32, 1023, v32
  v_cmp_ne_u32 vcc, 0, v32
  s_cbranch_vccz L_poll_g_done
  s_sub_u32 s70, s70, 1
  s_cmp_eq_u32 s70, 0
  s_cbranch_scc1 L_poll_g_done
  s_sleep 32
  s_branch L_poll_g
L_poll_g_done:
  s_nop 4
  s_waitcnt vmcnt(0)
  v_and_b32 v23, 0xffff0000, v22
  v_lshlrev_b32 v22, 16, v22
  v_mov_b32 v3, 151056
  s_mov_b64 exec, 1
  ds_write_b128 v3, v[24:27]
  s_mov_b64 exec, -1
  v_lshlrev_b32 v3, 3, v1
  v_add_u32 v3, 151072, v3
  s_mov_b64 exec, 3
  ds_write_b64 v3, v[22:23]
  s_mov_b64 exec, -1
  s_waitcnt lgkmcnt(0)
  v_mov_b32 v3, 151044
  v_mov_b32 v4, 1
  ds_write_b32 v3, v4
  s_waitcnt lgkmcnt(0)
  v_mov_b32 v40, 151096
  s_mov_b32 s70, 240000
L_ckw3:
  ds_read_b64 v[42:43], v40
  s_waitcnt lgkmcnt(0)
  v_readfirstlane_b32 s76, v42
  v_readfirstlane_b32 s84, v43
  s_cmp_ge_u32 s76, 4
  s_cbranch_scc1 L_cko3
  s_sub_u32 s70, s70, 1
  s_cmp_lg_u32 s70, 0
  s_cbranch_scc0 L_cko3
  s_sleep 6
  s_branch L_ckw3
L_cko3:
  s_cmp_gt_u32 s76, 4
  s_cbranch_scc1 L_ckskip3
  s_sub_u32 s76, s68, s67
  s_and_b32 s76, s76, 15
  s_lshl_b32 s76, s76, 7
  s_add_u32 s76, s76, 219136
  s_lshl_b32 s77, s67, 3
  s_add_u32 s77, s77, s76
  v_mov_b32 v44, s84
  v_mov_b32 v45, s66
  v_mov_b32 v46, s77
  s_mov_b64 exec, 1
  buffer_store_dwordx2 v[44:45], v46, s[44:47], 0 offen sc1
  s_mov_b64 exec, -1
  v_and_b32 v46, 15, v1
  v_lshl_add_u32 v46, v46, 3, s76
  s_sleep 48
  buffer_load_dwordx2 v[44:45], v46, s[44:47], 0 offen sc1
  s_waitcnt vmcnt(0)
  s_memrealtime s[86:87]
  v_cmp_eq_u32 vcc, s66, v45
  s_waitcnt lgkmcnt(0)
  v_mov_b32 v47, s86
  v_cndmask_b32 v44, v47, v44, vcc
  v_subrev_u32 v44, s84, v44
  v_cvt_f32_i32 v44, v44
  s_nop 1
  v_add_f32_dpp v44, v44, v44 row_ror:8 row_mask:0xf bank_mask:0xf
  s_nop 1
  v_add_f32_dpp v44, v44, v44 row_ror:4 row_mask:0xf bank_mask:0xf
  s_nop 1
  v_add_f32_dpp v44, v44, v44 row_ror:2 row_mask:0xf bank_mask:0xf
  s_nop 1
  v_add_f32_dpp v44, v44, v44 row_ror:1 row_mask:0xf bank_mask:0xf
  s_mov_b32 s77, 0xc4200000
  s_mov_b32 s78, 0x44200000
  v_mov_b32 v46, 1
  v_cmp_gt_f32 vcc, s77, v44
  s_nop 1
  v_cndmask_b32 v46, v46, 2, vcc
  v_cmp_lt_f32 vcc, s78, v44
  s_nop 1
  v_cndmask_b32 v46, v46, 0, vcc
  v_mov_b32 v47, 151088
  ds_write_b32 v47, v46
L_ckskip3:
  v_mov_b32 v40, 151096
  s_mov_b32 s70, 240000
L_ckw4:
  ds_read_b64 v[42:43], v40
  s_waitcnt lgkmcnt(0)
  v_readfirstlane_b32 s76, v42
  v_readfirstlane_b32 s84, v43
  s_cmp_ge_u32 s76, 5
  s_cbranch_scc1 L_cko4
  s_sub_u32 s70, s70, 1
  s_cmp_lg_u32 s70, 0
  s_cbranch_scc0 L_cko4
  s_sleep 6
  s_branch L_ckw4
L_cko4:
  s_cmp_gt_u32 s76, 5
  s_cbranch_scc1 L_ckskip4
  s_sub_u32 s76, s68, s67
  s_and_b32 s76, s76, 15
  s_lshl_b32 s76, s76, 7
  s_add_u32 s76, s76, 221184
  s_lshl_b32 s77, s67, 3
  s_add_u32 s77, s77, s76
  v_mov_b32 v44, s84
  v_mov_b32 v45, s66
  v_mov_b32 v46, s77
  s_mov_b64 exec, 1
  buffer_store_dwordx2 v[44:45], v46, s[44:47], 0 offen sc1
  s_mov_b64 exec, -1
  v_and_b32 v46, 15, v1
  v_lshl_add_u32 v46, v46, 3, s76
  s_sleep 48
  buffer_load_dwordx2 v[44:45], v46, s[44:47], 0 offen sc1
  s_waitcnt vmcnt(0)
  s_memrealtime s[86:87]
  v_cmp_eq_u32 vcc, s66, v45
  s_waitcnt lgkmcnt(0)
  v_mov_b32 v47, s86
  v_cndmask_b32 v44, v47, v44, vcc
  v_subrev_u32 v44, s84, v44
  v_cvt_f32_i32 v44, v44
  s_nop 1
  v_add_f32_dpp v44, v44, v44 row_ror:8 row_mask:0xf bank_mask:0xf
  s_nop 1
  v_add_f32_dpp v44, v44, v44 row_ror:4 row_mask:0xf bank_mask:0xf
  s_nop 1
  v_add_f32_dpp v44, v44, v44 row_ror:2 row_mask:0xf bank_mask:0xf
  s_nop 1
  v_add_f32_dpp v44, v44, v44 row_ror:1 row_mask:0xf bank_mask:0xf
  s_mov_b32 s77, 0xc4200000
  s_mov_b32 s78, 0x44200000
  v_mov_b32 v46, 1
  v_cmp_gt_f32 vcc, s77, v44
  s_nop 1
  v_cndmask_b32 v46, v46, 2, vcc
  v_cmp_lt_f32 vcc, s78, v44
  s_nop 1
  v_cndmask_b32 v46, v46, 0, vcc
  v_mov_b32 v47, 151088
  ds_write_b32 v47, v46
L_ckskip4:
  v_mov_b32 v40, 151096
  s_mov_b32 s70, 240000
L_ckw5:
  ds_read_b64 v[42:43], v40
  s_waitcnt lgkmcnt(0)
  v_readfirstlane_b32 s76, v42
  v_readfirstlane_b32 s84, v43
  s_cmp_ge_u32 s76, 6
  s_cbranch_scc1 L_cko5
  s_sub_u32 s70, s70, 1
  s_cmp_lg_u32 s70, 0
  s_cbranch_scc0 L_cko5
  s_sleep 6
  s_branch L_ckw5
L_cko5:
  s_cmp_gt_u32 s76, 6
  s_cbranch_scc1 L_ckskip5
  s_sub_u32 s76, s68, s67
  s_and_b32 s76, s76, 15
  s_lshl_b32 s76, s76, 7
  s_add_u32 s76, s76, 223232
  s_lshl_b32 s77, s67, 3
  s_add_u32 s77, s77, s76
  v_mov_b32 v44, s84
  v_mov_b32 v45, s66
  v_mov_b32 v46, s77
  s_mov_b64 exec, 1
  buffer_store_dwordx2 v[44:45], v46, s[44:47], 0 offen sc1
  s_mov_b64 exec, -1
  v_and_b32 v46, 15, v1
  v_lshl_add_u32 v46, v46, 3, s76
  s_sleep 48
  buffer_load_dwordx2 v[44:45], v46, s[44:47], 0 offen sc1
  s_waitcnt vmcnt(0)
  s_memrealtime s[86:87]
  v_cmp_eq_u32 vcc, s66, v45
  s_waitcnt lgkmcnt(0)
  v_mov_b32 v47, s86
  v_cndmask_b32 v44, v47, v44, vcc
  v_subrev_u32 v44, s84, v44
  v_cvt_f32_i32 v44, v44
  s_nop 1
  v_add_f32_dpp v44, v44, v44 row_ror:8 row_mask:0xf bank_mask:0xf
  s_nop 1
  v_add_f32_dpp v44, v44, v44 row_ror:4 row_mask:0xf bank_mask:0xf
  s_nop 1
  v_add_f32_dpp v44, v44, v44 row_ror:2 row_mask:0xf bank_mask:0xf
  s_nop 1
  v_add_f32_dpp v44, v44, v44 row_ror:1 row_mask:0xf bank_mask:0xf
  s_mov_b32 s77, 0xc4200000
  s_mov_b32 s78, 0x44200000
  v_mov_b32 v46, 1
  v_cmp_gt_f32 vcc, s77, v44
  s_nop 1
  v_cndmask_b32 v46, v46, 2, vcc
  v_cmp_lt_f32 vcc, s78, v44
  s_nop 1
  v_cndmask_b32 v46, v46, 0, vcc
  v_mov_b32 v47, 151088
  ds_write_b32 v47, v46
L_ckskip5:
  v_mov_b32 v40, 151096
  s_mov_b32 s70, 240000
L_ckw6:
  ds_read_b64 v[42:43], v40
  s_waitcnt lgkmcnt(0)
  v_readfirstlane_b32 s76, v42
  v_readfirstlane_b32 s84, v43
  s_cmp_ge_u32 s76, 7
  s_cbranch_scc1 L_cko6
  s_sub_u32 s70, s70, 1
  s_cmp_lg_u32 s70, 0
  s_cbranch_scc0 L_cko6
  s_sleep 6
  s_branch L_ckw6
L_cko6:
  s_cmp_gt_u32 s76, 7
  s_cbranch_scc1 L_ckskip6
  s_sub_u32 s76, s68, s67
  s_and_b32 s76, s76, 15
  s_lshl_b32 s76, s76, 7
  s_add_u32 s76, s76, 225280
  s_lshl_b32 s77, s67, 3
  s_add_u32 s77, s77, s76
  v_mov_b32 v44, s84
  v_mov_b32 v45, s66
  v_mov_b32 v46, s77
  s_mov_b64 exec, 1
  buffer_store_dwordx2 v[44:45], v46, s[44:47], 0 offen sc1
  s_mov_b64 exec, -1
  v_and_b32 v46, 15, v1
  v_lshl_add_u32 v46, v46, 3, s76
  s_sleep 48
  buffer_load_dwordx2 v[44:45], v46, s[44:47], 0 offen sc1
  s_waitcnt vmcnt(0)
  s_memrealtime s[86:87]
  v_cmp_eq_u32 vcc, s66, v45
  s_waitcnt lgkmcnt(0)
  v_mov_b32 v47, s86
  v_cndmask_b32 v44, v47, v44, vcc
  v_subrev_u32 v44, s84, v44
  v_cvt_f32_i32 v44, v44
  s_nop 1
  v_add_f32_dpp v44, v44, v44 row_ror:8 row_mask:0xf bank_mask:0xf
  s_nop 1
  v_add_f32_dpp v44, v44, v44 row_ror:4 row_mask:0xf bank_mask:0xf
  s_nop 1
  v_add_f32_dpp v44, v44, v44 row_ror:2 row_mask:0xf bank_mask:0xf
  s_nop 1
  v_add_f32_dpp v44, v44, v44 row_ror:1 row_mask:0xf bank_mask:0xf
  s_mov_b32 s77, 0xc4200000
  s_mov_b32 s78, 0x44200000
  v_mov_b32 v46, 1
  v_cmp_gt_f32 vcc, s77, v44
  s_nop 1
  v_cndmask_b32 v46, v46, 2, vcc
  v_cmp_lt_f32 vcc, s78, v44
  s_nop 1
  v_cndmask_b32 v46, v46, 0, vcc
  v_mov_b32 v47, 151088
  ds_write_b32 v47, v46
L_ckskip6:
  s_endpgm
L_exit:
  s_endpgm
L_codeend:
.section .rodata,"a"
.p2align 6
.amdhsa_kernel recurrent_scan__gqa_block_cached__dense_activation_gelu__decode_kernel
  .amdhsa_next_free_vgpr 256
  .amdhsa_next_free_sgpr 100
  .amdhsa_accum_offset 256
  .amdhsa_group_segment_fixed_size 0
  .amdhsa_kernarg_size 104
  .amdhsa_user_sgpr_count 2
  .amdhsa_user_sgpr_kernarg_segment_ptr 1
  .amdhsa_system_sgpr_workgroup_id_x 1
.end_amdhsa_kernel
```
